```python
import torch

def _softmax(x, axis=-1):
    return torch.softmax(x, dim=axis)
def _gelu(x):
    return torch.nn.functional.gelu(x, approximate="tanh")
def _silu(x):
    return torch.nn.functional.silu(x)
def _sigmoid(x):
    return torch.sigmoid(x)
def _layernorm(x, axis=-1, eps=1e-5):
    m = x.mean(dim=axis, keepdim=True)
    v = x.var(dim=axis, keepdim=True, unbiased=False)
    return (x - m) / torch.sqrt(v + eps)
def _scatter_add(tgt, idx, src, axis=0):
    return tgt.clone().index_add_(axis, idx, src)
def _segment_sum(src, seg, n):
    out = torch.zeros((n,) + src.shape[1:], dtype=src.dtype)
    return out.index_add_(0, seg, src)
def _pad(x, pw):
    flat = tuple(v for pair in reversed(pw) for v in pair)
    return torch.nn.functional.pad(x, flat)

kernel_name = 'parallel_sum__ssm_conv_h3__dense_activation_silu__prompt'

def setup_inputs():

    _w = (lambda a: (lambda t: t.to(torch.bfloat16) if t.is_floating_point() else t)(torch.as_tensor(a)))
    def _A_setup():
        B, S, D = 1, 2048, 640
        ks = 4
        return {
            "q": _w((lambda *s: torch.randn(*s, dtype=torch.bfloat16) * 0.05)(B, S, D)),
            "k": _w((lambda *s: torch.randn(*s, dtype=torch.bfloat16) * 0.2)(B, S, D)),
            "v": _w((lambda *s: torch.randn(*s, dtype=torch.bfloat16) * 0.2)(B, S, D)),
            "shift_k": _w((lambda *s: torch.randn(*s, dtype=torch.bfloat16) * 0.2)(D, ks) * 0.5),
            "ssm_k": _w((lambda *s: torch.randn(*s, dtype=torch.bfloat16) * 0.4)(D, S) * (1.0 / S ** 0.5)),
            "ssm_D": _w((lambda *s: torch.randn(*s, dtype=torch.bfloat16) * 0.2)(D)),
        }
    _A_in = _A_setup()

    def _B_setup():
        B, S, D, F = 1, 2048, 640, 1728
        return {
            "x": _w((lambda *s: torch.randn(*s, dtype=torch.bfloat16) * 0.05)(B, S, D)),
            "w1": _w((lambda *s: torch.randn(*s, dtype=torch.bfloat16) * 0.8)(D, F) * (D ** -0.5)),
            "w2": _w((lambda *s: torch.randn(*s, dtype=torch.bfloat16) * 0.1)(F, D) * (F ** -0.5)),
        }
    _B_in = _B_setup()

    return {
        "A_q": _A_in["q"],
        "A_k": _A_in["k"],
        "A_v": _A_in["v"],
        "A_shift_k": _A_in["shift_k"],
        "A_ssm_k": _A_in["ssm_k"],
        "A_ssm_D": _A_in["ssm_D"],
        "B_x": _B_in["x"],
        "B_w1": _B_in["w1"],
        "B_w2": _B_in["w2"],
    }

def reference(A_q, A_k, A_v, A_shift_k, A_ssm_k, A_ssm_D, B_x, B_w1, B_w2):
    def _A_ref(q, k, v, shift_k, ssm_k, ssm_D):
        B, S, D = q.shape
        ks = shift_k.shape[-1]
        k_pad = _pad(k, ((0, 0), (ks - 1, 0), (0, 0)))
        k_shift = torch.zeros_like(k)
        for t in range(ks):
            k_shift = k_shift + k_pad[:, t:t + S, :] * shift_k[:, ks - 1 - t][None, None, :]
        kv = k_shift * v
        L = 2 * S
        kv_pad = _pad(kv, ((0, 0), (0, S), (0, 0)))
        kf_pad = _pad(ssm_k, ((0, 0), (0, S)))
        kv_f = (lambda x, axes=(-2,-1): torch.fft.rfft2(x.float(), dim=axes))(kv_pad[:, None, :, :], axes=(1, 2))
        kf_f = (lambda x, axes=(-2,-1): torch.fft.rfft2(x.float(), dim=axes))(kf_pad[:, None, :], axes=(1, 2))
        kf_f = (lambda x, *d: x.permute(*d))(kf_f, 1, 2, 0)
        y_f = kv_f * kf_f[None, :, :, :]
        y = (lambda x, s, axes=(-2,-1): torch.fft.irfft2(x, s=s, dim=axes).to(torch.bfloat16))(y_f, (1, L), axes=(1, 2))[:, 0, :S, :]
        y = y + kv * ssm_D[None, None, :]
        return q * y

    def _B_ref(x, w1, w2):
        h = torch.einsum("bsd,df->bsf", x, w1)
        h = _silu(h)
        out = torch.einsum("bsf,fd->bsd", h, w2)
        return out

    x = A_q
    xn = _layernorm(x, axis=-1)
    return x + _A_ref(xn, A_k, A_v, A_shift_k, A_ssm_k, A_ssm_D) + _B_ref(xn, B_w1, B_w2)
```

```asm
; @launch grid=(256,1,1) block=(256,1,1) lds=162816
.amdgcn_target "amdgcn-amd-amdhsa--gfx950"
.text

.p2align 12
.globl parallel_sum__ssm_conv_h3__dense_activation_silu__prompt_kernel
.p2align 8
.type parallel_sum__ssm_conv_h3__dense_activation_silu__prompt_kernel,@function
parallel_sum__ssm_conv_h3__dense_activation_silu__prompt_kernel:

s_load_dwordx2 s[4:5], s[0:1], 0
s_load_dwordx2 s[28:29], s[0:1], 56
s_load_dwordx2 s[8:9], s[0:1], 8
s_load_dwordx2 s[12:13], s[0:1], 16
s_load_dwordx2 s[16:17], s[0:1], 24
s_load_dwordx2 s[44:45], s[0:1], 88
s_load_dwordx2 s[32:33], s[0:1], 64
s_cmp_ge_u32 s2, 256
s_cbranch_scc1 L_end
v_lshrrev_b32 v1, 6, v0
s_and_b32 s48, s2, 7
s_lshr_b32 s49, s2, 3
s_and_b32 s62, s48, 3
v_readfirstlane_b32 s50, v1
s_getpc_b64 s[60:61]
s_mul_i32 s3, s49, 1280
v_min_u32 v20, 9, v0
v_lshl_add_u32 v20, v20, 7, s3
s_and_b32 s60, s60, 0xffffff00
global_load_dword v255, v20, s[60:61]

v_and_b32 v1, 63, v0
s_lshr_b32 s75, s48, 2
s_lshl_b32 s62, s62, 2
s_sub_u32 s64, s49, 4
s_mul_i32 s65, s64, 37
s_lshr_b32 s65, s65, 8
s_mul_i32 s3, s65, 7
s_sub_u32 s64, s64, s3
s_cmp_lt_u32 s49, 4
s_cselect_b32 s65, s49, s65
s_cselect_b32 s64, 7, s64
s_add_u32 s51, s62, s65
s_lshl_b32 s68, s51, 7
s_mov_b32 s6, 2621440
s_mov_b32 s7, 0x20000
s_mov_b32 s46, 17301504
s_mov_b32 s47, 0x20000
s_cmp_lt_u32 s49, 4
s_cbranch_scc1 L_A
s_mul_i32 s52, s75, 7
s_add_u32 s52, s52, s64
s_mov_b32 s30, 2211840
s_mov_b32 s31, 0x20000
s_mul_i32 s3, s52, 2
s_mul_i32 s66, s51, 2
s_add_u32 s3, s3, s66
s_lshr_b32 s3, s3, 1
s_mul_i32 s66, s3, 205
s_lshr_b32 s66, s66, 11
s_mul_i32 s66, s66, 10
s_sub_u32 s3, s3, s66
s_lshl_b32 s56, s3, 7
s_mul_i32 s57, s3, 221184
s_lshl_b32 s58, s50, 12
s_add_u32 s59, s58, 49152
v_lshrrev_b32 v20, 3, v1
v_lshrrev_b32 v21, 4, v1
s_lshl_b32 s3, s51, 7
s_lshl_b32 s66, s50, 5
s_add_u32 s3, s3, s66
v_add_u32 v20, s3, v20
v_mul_u32_u24 v20, 1280, v20
v_and_b32 v22, 7, v1
v_xor_b32 v22, v22, v21
v_lshl_add_u32 v4, v22, 4, v20
v_xor_b32 v5, 64, v4
v_add_u32 v6, 18432, v4
v_add_u32 v7, 27648, v5
v_add_u32 v5, 9216, v5
s_lshr_b32 s3, s50, 1
s_and_b32 s66, s50, 1
s_lshl_b32 s67, s3, 5
s_lshl_b32 s69, s66, 2
s_add_u32 s67, s67, s69
v_add_u32 v20, s67, v21
v_mul_u32_u24 v20, 3456, v20
v_and_b32 v22, 15, v1
v_lshlrev_b32 v23, 1, v21
v_xor_b32 v23, v23, v22
v_lshlrev_b32 v23, 4, v23
s_lshl_b32 s67, s52, 8
v_add3_u32 v8, v20, v23, s67
v_xor_b32 v23, 128, v23
v_add3_u32 v9, v20, v23, s67
v_add_u32 v10, 53248, v8
v_add_u32 v11, 79872, v9
v_add_u32 v9, 26624, v9
s_cmp_eq_u32 s52, 13
s_cselect_b32 s3, 128, 0
v_and_b32 v22, s3, v23
v_xor_b32 v23, s3, v22
v_lshl_or_b32 v9, v22, 24, v9
v_lshl_or_b32 v11, v22, 24, v11
v_lshl_or_b32 v8, v23, 24, v8
v_lshl_or_b32 v10, v23, 24, v10
s_mov_b32 s61, s64
s_cmp_lt_u32 s61, 4
s_cbranch_scc1 L_kvjob
s_sub_u32 s3, s64, 4
s_mul_i32 s3, s3, 22
s_sub_u32 s63, 64, s3
s_min_u32 s63, s63, 22
s_add_u32 s71, s68, 5288960
s_add_u32 s3, s3, s68
s_lshl_b32 s69, s75, 6
s_add_u32 s3, s3, s69
v_lshrrev_b32 v20, 3, v0
v_cmp_gt_u32 vcc, s63, v20
v_add_u32 v156, s3, v20
v_mov_b32 v21, 0x100000
v_cndmask_b32 v156, v21, v156, vcc
v_and_b32 v157, 7, v0
v_mul_u32_u24 v20, 1280, v156
v_lshl_add_u32 v158, v157, 4, v20
s_waitcnt lgkmcnt(0)
buffer_load_dwordx4 v[116:119], v158, s[4:7], 0 offen offset:0
buffer_load_dwordx4 v[120:123], v158, s[4:7], 0 offen offset:128
buffer_load_dwordx4 v[124:127], v158, s[4:7], 0 offen offset:256
buffer_load_dwordx4 v[128:131], v158, s[4:7], 0 offen offset:384
buffer_load_dwordx4 v[132:135], v158, s[4:7], 0 offen offset:512
buffer_load_dwordx4 v[136:139], v158, s[4:7], 0 offen offset:640
buffer_load_dwordx4 v[140:143], v158, s[4:7], 0 offen offset:768
buffer_load_dwordx4 v[144:147], v158, s[4:7], 0 offen offset:896
buffer_load_dwordx4 v[148:151], v158, s[4:7], 0 offen offset:1024
buffer_load_dwordx4 v[152:155], v158, s[4:7], 0 offen offset:1152
v_bfrev_b32 v28, 1
v_bfrev_b32 v29, 1
s_branch L_gmid
L_kvjob:
s_mov_b32 s10, 2621440
s_mov_b32 s11, 0x20000
s_mov_b32 s14, 2621440
s_mov_b32 s15, 0x20000
s_mov_b32 s18, 5120
s_mov_b32 s19, 0x20000
s_mul_i32 s69, s75, 5
s_lshr_b32 s3, s64, 1
s_add_u32 s69, s69, s3
s_add_u32 s69, s69, 3
s_and_b32 s70, s64, 1
s_lshl_b32 s3, s51, 1
s_add_u32 s70, s70, s3
s_lshl_b32 s71, s69, 7
s_lshl_b32 s3, s70, 6
s_lshl_b32 s63, s50, 4
s_add_u32 s3, s3, s63
v_lshrrev_b32 v20, 3, v1
v_and_b32 v21, 7, v1
v_lshlrev_b32 v22, 4, v21
v_add_u32 v23, s3, v20
v_mul_u32_u24 v23, 1280, v23
v_add3_u32 v24, v23, v22, s71
s_cmp_eq_u32 s50, 0
s_cselect_b32 s72, 5, 8
s_cselect_b32 s73, 0, 17680
s_cmp_eq_u32 s70, 0
s_cselect_b32 s72, 8, s72
v_cmp_le_u32 vcc, s72, v20
v_subrev_u32 v26, 10240, v24
v_mov_b32 v23, 2147483648
v_cndmask_b32 v26, v23, v26, vcc
v_add_u32 v25, 9200, v24
v_lshrrev_b32 v28, 3, v0
s_lshl_b32 s3, s69, 9
v_lshl_add_u32 v30, v28, 4, s3
s_mul_i32 s72, s50, 2080
s_add_u32 m0, s73, 98368
v_xor_b32 v21, 7, v21
v_mul_u32_u24 v27, 1040, v21
v_lshl_add_u32 v27, v28, 2, v27
v_add_u32 v27, 98368, v27
v_lshl_add_u32 v28, v28, 13, v22
s_waitcnt lgkmcnt(0)
buffer_load_dwordx4 v26, s[8:11], 0 offen lds
s_add_u32 m0, s72, 99408
s_nop 0
buffer_load_dwordx4 v24, s[8:11], 0 offen offset:0 nt lds
buffer_load_dwordx4 v25, s[8:11], 0 offen offset:1040 nt lds
s_add_u32 m0, s72, 107728
s_nop 0
buffer_load_dwordx4 v24, s[12:15], 0 offen offset:0 nt lds
buffer_load_dwordx4 v25, s[12:15], 0 offen offset:1040 nt lds
buffer_load_dwordx4 v[52:55], v30, s[16:19], 0 offen
s_lshl_b32 s3, s69, 18
s_lshl_b32 s63, s70, 7
s_sub_u32 s3, s3, s63
s_add_u32 s3, s3, 3968
v_add_u32 v28, s3, v28
v_add_u32 v29, 4096, v28
s_add_u32 s71, s71, 5291008
s_mov_b32 s34, 2211840
s_mov_b32 s35, 0x20000
s_lshl_b32 s69, s51, 2
s_add_u32 s69, s69, s64
s_lshr_b32 s70, s69, 1
s_mul_i32 s63, s75, 28
s_add_u32 s63, s63, s70
s_lshl_b32 s63, s63, 2
s_add_u32 s63, s63, s50
s_mul_i32 s63, s63, 10240
s_and_b32 s3, s69, 1
s_lshl_b32 s3, s3, 7
s_add_u32 s63, s63, s3
s_add_u32 s63, s63, 1024
s_cmp_lt_u32 s69, 56
s_cselect_b32 s63, s63, 2147483648
v_and_b32 v21, 6, v20
v_lshlrev_b32 v21, 4, v21
v_xor_b32 v21, v21, v22
v_mul_u32_u24 v20, 1280, v20
s_lshl_b32 s3, s50, 10
s_add_u32 m0, s3, 118784
v_add3_u32 v20, v20, v21, s63
buffer_load_dwordx4 v20, s[32:35], 0 offen nt lds
L_gmid:
s_add_u32 m0, s58, 0
s_nop 0
buffer_load_dwordx4 v4, s[4:7], s56 offen offset:0 lds
buffer_load_dwordx4 v5, s[4:7], s56 offen offset:1024 lds
buffer_load_dwordx4 v6, s[4:7], s56 offen offset:2048 lds
buffer_load_dwordx4 v7, s[4:7], s56 offen offset:3072 lds
s_add_u32 m0, s59, 0
s_add_u32 s56, s56, 128
buffer_load_dwordx4 v8, s[28:31], s57 offen offset:0 lds
buffer_load_dwordx4 v9, s[28:31], s57 offen offset:1024 lds
buffer_load_dwordx4 v10, s[28:31], s57 offen offset:2048 lds
buffer_load_dwordx4 v11, s[28:31], s57 offen offset:3072 lds
s_sub_u32 s57, s56, 1280
s_min_u32 s56, s56, s57
s_mul_i32 s57, s56, 1728
s_branch L_gmid2
L_A:
s_mov_b32 s10, 2621440
s_mov_b32 s11, 0x20000
s_mov_b32 s14, 2621440
s_mov_b32 s15, 0x20000
s_mov_b32 s18, 5120
s_mov_b32 s19, 0x20000
s_lshl_b32 s64, s50, 5
s_add_u32 s64, s64, s68
v_lshrrev_b32 v20, 3, v1
v_and_b32 v21, 7, v1
v_lshlrev_b32 v21, 4, v21
s_mul_i32 s65, s75, 640
v_add_u32 v22, s64, v20
v_mul_u32_u24 v22, 1280, v22
v_add3_u32 v4, v22, v21, s65
s_cmp_eq_u32 s50, 0
s_cselect_b32 s66, 5, 8
s_cselect_b32 s57, 0, 34320
s_cmp_eq_u32 s51, 0
s_cselect_b32 s66, 8, s66
v_cmp_le_u32 vcc, s66, v20
v_subrev_u32 v8, 10240, v4
v_mov_b32 v22, 2147483648
v_cndmask_b32 v8, v22, v8, vcc
v_add_u32 v5, 9200, v4
v_add_u32 v6, 18400, v4
v_add_u32 v7, 27600, v4
s_mul_i32 s56, s50, 4160
v_lshlrev_b32 v19, 4, v0
s_lshl_b32 s3, s50, 10
s_add_u32 m0, s3, 106080
s_mul_i32 s3, s75, 2560
s_cmp_eq_u32 s2, 0
s_waitcnt lgkmcnt(0)
s_cbranch_scc1 LS_init
LR_init:
buffer_load_dwordx4 v19, s[16:19], s3 offen lds
s_add_u32 m0, s57, 0
s_mov_b32 s58, 0
buffer_load_dwordx4 v8, s[8:11], s58 offen lds
s_add_u32 m0, s56, 1040
s_nop 0
buffer_load_dwordx4 v4, s[8:11], s58 offen offset:0 nt lds
buffer_load_dwordx4 v5, s[8:11], s58 offen offset:1040 nt lds
buffer_load_dwordx4 v6, s[8:11], s58 offen offset:2080 nt lds
buffer_load_dwordx4 v7, s[8:11], s58 offen offset:3120 nt lds
s_add_u32 m0, s56, 17680
s_nop 0
buffer_load_dwordx4 v4, s[12:15], s58 offen offset:0 nt lds
buffer_load_dwordx4 v5, s[12:15], s58 offen offset:1040 nt lds
buffer_load_dwordx4 v6, s[12:15], s58 offen offset:2080 nt lds
buffer_load_dwordx4 v7, s[12:15], s58 offen offset:3120 nt lds
s_branch L_A2
L_gmid2:
v_lshlrev_b32 v19, 4, v0
s_load_dwordx2 s[20:21], s[0:1], 32
s_load_dwordx2 s[24:25], s[0:1], 40
s_load_dwordx2 s[36:37], s[0:1], 72
s_load_dwordx2 s[40:41], s[0:1], 80
s_mov_b32 s22, 2621440
s_mov_b32 s23, 0x20000
s_mov_b32 s26, 1280
s_mov_b32 s27, 0x20000
s_mov_b32 s38, 2621440
s_mov_b32 s39, 0x20000
s_mov_b32 s42, 256
s_mov_b32 s43, 0x20000
s_mov_b32 s34, 2211840
s_mov_b32 s35, 0x20000
v_lshlrev_b32 v18, 4, v1
v_mov_b32 v3, 1
v_min_u32 v2, 1, v0
v_lshlrev_b32 v2, 31, v2
s_lshr_b32 s3, s49, 3
s_add_u32 s53, s62, s3
s_and_b32 s54, s49, 7
s_mul_i32 s55, s48, 80
s_lshr_b32 s3, s49, 1
s_mul_i32 s3, s3, 5
s_add_u32 s55, s55, s3
s_lshr_b32 s3, s50, 1
s_and_b32 s66, s50, 1
v_and_b32 v20, 15, v1
v_lshrrev_b32 v21, 4, v1
v_lshrrev_b32 v22, 1, v20
v_xor_b32 v22, v22, v21
v_lshlrev_b32 v22, 4, v22
v_lshl_add_u32 v22, v20, 7, v22
s_lshl_b32 s67, s3, 13
v_add_u32 v12, s67, v22
v_xor_b32 v13, 64, v12
v_lshrrev_b32 v20, 2, v1
v_and_b32 v21, 7, v20
s_lshl_b32 s66, s66, 1
s_add_u32 s66, s66, s3
s_lshl_b32 s66, s66, 1
v_xor_b32 v21, s66, v21
v_lshlrev_b32 v21, 5, v21
v_lshl_add_u32 v21, v20, 8, v21
v_and_b32 v20, 3, v1
v_lshl_add_u32 v21, v20, 3, v21
v_add_u32 v14, 49152, v21
v_xor_b32 v15, 32, v14
v_xor_b32 v16, 64, v14
v_xor_b32 v17, 96, v14
s_and_b32 s3, s49, 1
s_lshl_b32 s3, s3, 1
s_add_u32 s3, s3, s55
s_lshl_b32 s72, s3, 12
s_add_u32 s73, s72, 4096
s_add_u32 s3, s55, 4
s_lshl_b32 s74, s3, 12
v_mov_b32 v172, 0x3f803f80
v_mov_b32 v173, 0x3f803f80
v_mov_b32 v174, 0x3f803f80
v_mov_b32 v175, 0x3f803f80
v_and_b32 v176, 15, v1
s_lshl_b32 s3, s51, 7
s_add_u32 s3, s3, 5288960
v_mov_b32 v251, s3
s_lshr_b32 s3, s50, 1
s_lshl_b32 s3, s3, 6
s_lshl_b32 s62, s51, 7
s_add_u32 s3, s3, s62
s_lshl_b32 s3, s3, 3
s_add_u32 s3, s3, 5242880
v_lshl_add_u32 v176, v176, 3, s3
v_and_b32 v177, 0x30, v1
s_lshl_b32 s3, s50, 7
s_add_u32 s3, s3, 162304
v_add_u32 v177, s3, v177
v_xor_b32 v178, 256, v177

v_or_b32 v242, s71, v2
v_lshrrev_b32 v180, 2, v1
v_min_u32 v180, 2, v180
v_min_u32 v181, 1, v180
v_lshl_add_u32 v239, v181, 12, s72
v_lshrrev_b32 v181, 1, v180
s_sub_u32 s3, s74, s73
v_mad_u32_u24 v239, v181, s3, v239
v_mul_u32_u24 v180, 21248, v180
v_and_b32 v181, 3, v1
v_mul_u32_u24 v181, 4162, v181
s_min_u32 s3, s50, 1
s_mul_i32 s3, s3, 4098
s_add_u32 s3, s3, 98336
v_add3_u32 v240, v180, v181, s3
s_lshl_b32 s65, s53, 3
s_lshl_b32 s66, s75, 2
s_add_u32 s65, s65, s66
s_lshl_b32 s3, s65, 5
s_add_u32 s3, s3, 5275648
v_mov_b32 v218, s3
s_add_u32 s67, s50, s54
s_and_b32 s67, s67, 3
s_mul_i32 s64, s75, 28
s_mul_i32 s62, s50, 7
s_add_u32 s64, s64, s62
s_xor_b32 s66, s65, 4
s_sub_u32 s12, s65, s66
s_mul_i32 s12, s12, 57344
s_mul_i32 s66, s66, 56
s_add_u32 s66, s66, s64
s_lshl_b32 s66, s66, 10
s_add_u32 s66, s66, 6291456
s_add_u32 s3, s67, 1
s_and_b32 s3, s3, 3
s_mul_i32 s62, s3, 57344
s_add_u32 s8, s62, s66
s_mul_i32 s3, s3, 15360
s_add_u32 s13, s3, 0
s_add_u32 s3, s67, 2
s_and_b32 s3, s3, 3
s_mul_i32 s62, s3, 57344
s_add_u32 s9, s62, s66
s_mul_i32 s3, s3, 15360
s_add_u32 s14, s3, 5120
s_add_u32 s3, s67, 3
s_and_b32 s3, s3, 3
s_mul_i32 s62, s3, 57344
s_add_u32 s10, s62, s66
s_mul_i32 s3, s3, 15360
s_add_u32 s15, s3, 10240
s_add_u32 s3, s67, 4
s_and_b32 s3, s3, 3
s_mul_i32 s62, s3, 57344
s_add_u32 s11, s62, s66
s_lshl_b32 s3, s50, 12
s_add_u32 s62, s3, 140800
v_add_u32 v222, s62, v18
s_xor_b32 s62, s3, 4096
s_add_u32 s62, s62, 140800
v_add_u32 v223, s62, v18
s_lshr_b32 s3, s3, 13
s_lshl_b32 s3, s3, 12
s_add_u32 s3, s3, s72
s_add_u32 s69, s3, 2621440
v_and_b32 v180, 15, v1
v_lshrrev_b32 v181, 4, v1
v_and_b32 v182, 1, v181
v_lshlrev_b32 v217, 9, v182
v_lshl_add_u32 v217, v180, 5, v217
v_lshrrev_b32 v182, 1, v181
v_lshl_add_u32 v217, v182, 4, v217
s_lshl_b32 s3, s48, 7
s_add_u32 s3, s3, 5279744
v_or_b32 v241, s3, v2
v_lshlrev_b32 v235, 3, v1
s_lshl_b32 s3, s2, 2
s_add_u32 s3, s3, s50
s_mul_i32 s19, s3, 3072
s_add_u32 s19, s19, 13631488
s_xor_b32 s62, s3, 16
s_mul_i32 s18, s62, 3072
s_add_u32 s18, s18, 13631488
s_lshr_b32 s3, s62, 4
s_lshl_b32 s3, s3, 7
s_and_b32 s62, s62, 15
s_lshl_b32 s62, s62, 2
s_add_u32 s3, s3, s62
s_add_u32 s3, s3, 5280768
v_min_u32 v180, 1, v1
v_lshl_or_b32 v234, v180, 31, s3
s_xor_b32 s3, s3, 128
v_mov_b32 v237, s3
v_accvgpr_write_b32 a252, -1
v_accvgpr_write_b32 a253, -1
v_accvgpr_write_b32 a254, -1
v_accvgpr_write_b32 a255, -1
s_and_b32 s16, s50, 1
s_lshl_b32 s16, s16, 11
s_add_u32 s16, s16, s69
s_lshr_b32 s3, s49, 3
s_mul_i32 s60, s3, 2
s_mul_i32 s3, s75, 28
s_mul_i32 s62, s50, 7
s_add_u32 s3, s3, s62
s_mul_i32 s3, s3, 40960
s_lshl_b32 s62, s54, 7
s_add_u32 s3, s3, s62
v_lshrrev_b32 v180, 3, v1
v_and_b32 v181, 6, v180
v_and_b32 v182, 7, v1
v_xor_b32 v181, v181, v182
v_lshlrev_b32 v181, 4, v181
v_mul_u32_u24 v180, 1280, v180
v_add3_u32 v244, v180, v181, s3
s_cmp_lt_u32 s61, 4
s_cbranch_scc1 L_kvjob2
v_lshrrev_b32 v20, 20, v156
v_or_b32 v157, v157, v20
v_min_u32 v157, 1, v157
v_lshlrev_b32 v157, 31, v157
v_lshl_add_u32 v156, v156, 3, v157
v_add_u32 v156, 5242880, v156
v_mov_b32 v20, 0x3f803f80
v_mov_b32 v112, 0
v_mov_b32 v113, 0
v_mov_b32 v114, 0
v_mov_b32 v115, 0
s_waitcnt vmcnt(8) lgkmcnt(0)
s_add_u32 m0, s58, 16384
s_nop 0
buffer_load_dwordx4 v4, s[4:7], s56 offen offset:0 lds
buffer_load_dwordx4 v5, s[4:7], s56 offen offset:1024 lds
buffer_load_dwordx4 v6, s[4:7], s56 offen offset:2048 lds
buffer_load_dwordx4 v7, s[4:7], s56 offen offset:3072 lds
v_dot2c_f32_bf16 v112, v116, v20
v_dot2c_f32_bf16 v114, v116, v116
v_dot2c_f32_bf16 v113, v117, v20
v_dot2c_f32_bf16 v115, v117, v117
v_dot2c_f32_bf16 v112, v118, v20
v_dot2c_f32_bf16 v114, v118, v118
v_dot2c_f32_bf16 v113, v119, v20
v_dot2c_f32_bf16 v115, v119, v119
v_dot2c_f32_bf16 v112, v120, v20
v_dot2c_f32_bf16 v114, v120, v120
v_dot2c_f32_bf16 v113, v121, v20
v_dot2c_f32_bf16 v115, v121, v121
v_dot2c_f32_bf16 v112, v122, v20
v_dot2c_f32_bf16 v114, v122, v122
v_dot2c_f32_bf16 v113, v123, v20
v_dot2c_f32_bf16 v115, v123, v123
v_dot2c_f32_bf16 v112, v124, v20
v_dot2c_f32_bf16 v114, v124, v124
v_dot2c_f32_bf16 v113, v125, v20
v_dot2c_f32_bf16 v115, v125, v125
v_dot2c_f32_bf16 v112, v126, v20
v_dot2c_f32_bf16 v114, v126, v126
v_dot2c_f32_bf16 v113, v127, v20
v_dot2c_f32_bf16 v115, v127, v127
v_dot2c_f32_bf16 v112, v128, v20
v_dot2c_f32_bf16 v114, v128, v128
v_dot2c_f32_bf16 v113, v129, v20
v_dot2c_f32_bf16 v115, v129, v129
v_dot2c_f32_bf16 v112, v130, v20
v_dot2c_f32_bf16 v114, v130, v130
v_dot2c_f32_bf16 v113, v131, v20
v_dot2c_f32_bf16 v115, v131, v131
v_dot2c_f32_bf16 v112, v132, v20
v_dot2c_f32_bf16 v114, v132, v132
v_dot2c_f32_bf16 v113, v133, v20
v_dot2c_f32_bf16 v115, v133, v133
v_dot2c_f32_bf16 v112, v134, v20
v_dot2c_f32_bf16 v114, v134, v134
v_dot2c_f32_bf16 v113, v135, v20
v_dot2c_f32_bf16 v115, v135, v135
s_add_u32 m0, s59, 16384
s_add_u32 s56, s56, 128
buffer_load_dwordx4 v8, s[28:31], s57 offen offset:0 lds
buffer_load_dwordx4 v9, s[28:31], s57 offen offset:1024 lds
buffer_load_dwordx4 v10, s[28:31], s57 offen offset:2048 lds
buffer_load_dwordx4 v11, s[28:31], s57 offen offset:3072 lds
s_sub_u32 s57, s56, 1280
s_min_u32 s56, s56, s57
s_mul_i32 s57, s56, 1728
v_dot2c_f32_bf16 v112, v136, v20
v_dot2c_f32_bf16 v114, v136, v136
v_dot2c_f32_bf16 v113, v137, v20
v_dot2c_f32_bf16 v115, v137, v137
v_dot2c_f32_bf16 v112, v138, v20
v_dot2c_f32_bf16 v114, v138, v138
v_dot2c_f32_bf16 v113, v139, v20
v_dot2c_f32_bf16 v115, v139, v139
v_dot2c_f32_bf16 v112, v140, v20
v_dot2c_f32_bf16 v114, v140, v140
v_dot2c_f32_bf16 v113, v141, v20
v_dot2c_f32_bf16 v115, v141, v141
v_dot2c_f32_bf16 v112, v142, v20
v_dot2c_f32_bf16 v114, v142, v142
v_dot2c_f32_bf16 v113, v143, v20
v_dot2c_f32_bf16 v115, v143, v143
v_dot2c_f32_bf16 v112, v144, v20
v_dot2c_f32_bf16 v114, v144, v144
v_dot2c_f32_bf16 v113, v145, v20
v_dot2c_f32_bf16 v115, v145, v145
v_dot2c_f32_bf16 v112, v146, v20
v_dot2c_f32_bf16 v114, v146, v146
v_dot2c_f32_bf16 v113, v147, v20
v_dot2c_f32_bf16 v115, v147, v147
v_dot2c_f32_bf16 v112, v148, v20
v_dot2c_f32_bf16 v114, v148, v148
v_dot2c_f32_bf16 v113, v149, v20
v_dot2c_f32_bf16 v115, v149, v149
v_dot2c_f32_bf16 v112, v150, v20
v_dot2c_f32_bf16 v114, v150, v150
v_dot2c_f32_bf16 v113, v151, v20
v_dot2c_f32_bf16 v115, v151, v151
v_dot2c_f32_bf16 v112, v152, v20
v_dot2c_f32_bf16 v114, v152, v152
v_dot2c_f32_bf16 v113, v153, v20
v_dot2c_f32_bf16 v115, v153, v153
v_dot2c_f32_bf16 v112, v154, v20
v_dot2c_f32_bf16 v114, v154, v154
v_dot2c_f32_bf16 v113, v155, v20
v_dot2c_f32_bf16 v115, v155, v155
s_nop 2
v_add_f32 v112, v112, v113
v_add_f32 v114, v114, v115
s_nop 0
v_add_f32_dpp v112, v112, v112 quad_perm:[1,0,3,2] row_mask:0xf bank_mask:0xf
v_add_f32_dpp v114, v114, v114 quad_perm:[1,0,3,2] row_mask:0xf bank_mask:0xf
s_nop 0
v_add_f32_dpp v112, v112, v112 quad_perm:[2,3,0,1] row_mask:0xf bank_mask:0xf
v_add_f32_dpp v114, v114, v114 quad_perm:[2,3,0,1] row_mask:0xf bank_mask:0xf
s_nop 0
v_add_f32_dpp v112, v112, v112 row_half_mirror row_mask:0xf bank_mask:0xf
v_add_f32_dpp v114, v114, v114 row_half_mirror row_mask:0xf bank_mask:0xf
s_nop 0
v_mul_f32 v112, 0x3acccccd, v112
v_mul_f32 v114, 0x3acccccd, v114
v_fma_f32 v114, -v112, v112, v114
v_max_f32 v114, 0, v114
v_cvt_pk_bf16_f32 v114, v114, v112
v_and_b32 v112, 0xffff0000, v114
v_lshlrev_b32 v114, 16, v114
v_add_f32 v114, 0x3727c5ac, v114
v_cvt_pk_bf16_f32 v114, v114, v114
v_lshlrev_b32 v114, 16, v114
v_sqrt_f32 v114, v114
s_nop 0
v_cvt_pk_bf16_f32 v114, v114, v114
v_lshlrev_b32 v114, 16, v114
v_rcp_f32 v113, v114
s_nop 0
buffer_store_dwordx2 v[112:113], v156, s[44:47], 0 offen sc1
buffer_load_dword v255, v28, s[4:7], 0 offen
buffer_load_dword v255, v28, s[4:7], 0 offen
s_waitcnt vmcnt(11) lgkmcnt(0)
s_branch L_g1
L_kvjob2:
s_lshl_b32 s0, s51, 2
s_add_u32 s0, s0, s61
s_cmp_lt_u32 s0, 56
s_cselect_b32 s1, 0, 2147483648
s_and_b32 s63, s0, 1
s_lshr_b32 s0, s0, 1
s_lshl_b32 s63, s63, 2
s_add_u32 s63, s63, s50
s_lshl_b32 s63, s63, 1
s_add_u32 s63, s63, s75
s_mul_i32 s63, s63, 28
s_add_u32 s63, s63, s0
s_lshl_b32 s63, s63, 10
s_add_u32 s63, s63, 16777216
s_or_b32 s63, s63, s1
v_add_u32 v121, s63, v18
v_bfe_u32 v20, v1, 3, 2
v_xor_b32 v20, s50, v20
v_lshlrev_b32 v20, 5, v20
v_lshrrev_b32 v21, 2, v1
v_lshl_add_u32 v20, v21, 7, v20
v_and_b32 v21, 3, v1
v_lshl_add_u32 v20, v21, 3, v20
v_add_u32 v120, 118784, v20
s_mul_i32 s0, s0, 37
s_lshr_b32 s0, s0, 8
s_lshl_b32 s63, s75, 2
s_add_u32 s0, s0, s63
s_lshl_b32 s0, s0, 7
s_add_u32 s0, s0, 5292288
s_or_b32 s0, s0, s1
v_cmp_eq_u32 vcc, 1, v0
v_mov_b32 v20, s0
s_nop 0
v_cndmask_b32 v242, v242, v20, vcc
s_waitcnt vmcnt(8) lgkmcnt(0)
s_barrier
ds_read_b32 v32, v27 offset:640
ds_read_b32 v33, v27 offset:768
ds_read_b32 v34, v27 offset:896
ds_read_b32 v35, v27 offset:1040
ds_read_b32 v36, v27 offset:1168
ds_read_b32 v37, v27 offset:1296
ds_read_b32 v38, v27 offset:1424
ds_read_b32 v39, v27 offset:1552
ds_read_b32 v40, v27 offset:1680
ds_read_b32 v41, v27 offset:1808
ds_read_b32 v42, v27 offset:1936
s_add_u32 m0, s58, 16384
s_nop 0
buffer_load_dwordx4 v4, s[4:7], s56 offen offset:0 lds
buffer_load_dwordx4 v5, s[4:7], s56 offen offset:1024 lds
buffer_load_dwordx4 v6, s[4:7], s56 offen offset:2048 lds
buffer_load_dwordx4 v7, s[4:7], s56 offen offset:3072 lds
v_lshlrev_b32 v78, 16, v52
v_and_b32 v80, 0xffff0000, v52
v_lshlrev_b32 v82, 16, v53
v_and_b32 v84, 0xffff0000, v53
v_lshlrev_b32 v79, 16, v54
v_and_b32 v81, 0xffff0000, v54
v_lshlrev_b32 v83, 16, v55
v_and_b32 v85, 0xffff0000, v55
s_waitcnt lgkmcnt(0)
ds_read_b32 v44, v27 offset:9360
ds_read_b32 v45, v27 offset:9488
ds_read_b32 v46, v27 offset:9616
ds_read_b32 v47, v27 offset:9744
ds_read_b32 v48, v27 offset:9872
ds_read_b32 v49, v27 offset:10000
ds_read_b32 v50, v27 offset:10128
ds_read_b32 v51, v27 offset:10256
ds_read_b64_tr_b16 v[116:117], v120 offset:0
ds_read_b64_tr_b16 v[118:119], v120 offset:2048
v_lshlrev_b32 v56, 16, v32
v_and_b32 v57, 0xffff0000, v32
v_lshlrev_b32 v58, 16, v33
v_and_b32 v59, 0xffff0000, v33
v_lshlrev_b32 v60, 16, v34
v_and_b32 v61, 0xffff0000, v34
v_lshlrev_b32 v62, 16, v35
v_and_b32 v63, 0xffff0000, v35
v_lshlrev_b32 v64, 16, v36
v_and_b32 v65, 0xffff0000, v36
v_lshlrev_b32 v66, 16, v37
v_and_b32 v67, 0xffff0000, v37
v_lshlrev_b32 v68, 16, v38
v_and_b32 v69, 0xffff0000, v38
v_lshlrev_b32 v70, 16, v39
v_and_b32 v71, 0xffff0000, v39
v_lshlrev_b32 v72, 16, v40
v_and_b32 v73, 0xffff0000, v40
v_lshlrev_b32 v74, 16, v41
v_and_b32 v75, 0xffff0000, v41
v_lshlrev_b32 v76, 16, v42
v_and_b32 v77, 0xffff0000, v42
s_add_u32 m0, s59, 16384
s_add_u32 s56, s56, 128
buffer_load_dwordx4 v8, s[28:31], s57 offen offset:0 lds
buffer_load_dwordx4 v9, s[28:31], s57 offen offset:1024 lds
buffer_load_dwordx4 v10, s[28:31], s57 offen offset:2048 lds
buffer_load_dwordx4 v11, s[28:31], s57 offen offset:3072 lds
s_sub_u32 s57, s56, 1280
s_min_u32 s56, s56, s57
s_mul_i32 s57, s56, 1728
.p2align 3
v_pk_mul_f32 v[86:87], v[62:63], v[78:79]
v_pk_mul_f32 v[88:89], v[64:65], v[78:79]
v_pk_mul_f32 v[90:91], v[66:67], v[78:79]
v_pk_mul_f32 v[92:93], v[68:69], v[78:79]
v_pk_mul_f32 v[94:95], v[70:71], v[78:79]
v_pk_mul_f32 v[96:97], v[72:73], v[78:79]
v_pk_mul_f32 v[98:99], v[74:75], v[78:79]
v_pk_mul_f32 v[100:101], v[76:77], v[78:79]
v_pk_fma_f32 v[86:87], v[60:61], v[80:81], v[86:87]
v_pk_fma_f32 v[88:89], v[62:63], v[80:81], v[88:89]
v_pk_fma_f32 v[90:91], v[64:65], v[80:81], v[90:91]
v_pk_fma_f32 v[92:93], v[66:67], v[80:81], v[92:93]
v_pk_fma_f32 v[94:95], v[68:69], v[80:81], v[94:95]
v_pk_fma_f32 v[96:97], v[70:71], v[80:81], v[96:97]
v_pk_fma_f32 v[98:99], v[72:73], v[80:81], v[98:99]
v_pk_fma_f32 v[100:101], v[74:75], v[80:81], v[100:101]
v_pk_fma_f32 v[86:87], v[58:59], v[82:83], v[86:87]
v_pk_fma_f32 v[88:89], v[60:61], v[82:83], v[88:89]
v_pk_fma_f32 v[90:91], v[62:63], v[82:83], v[90:91]
v_pk_fma_f32 v[92:93], v[64:65], v[82:83], v[92:93]
v_pk_fma_f32 v[94:95], v[66:67], v[82:83], v[94:95]
v_pk_fma_f32 v[96:97], v[68:69], v[82:83], v[96:97]
v_pk_fma_f32 v[98:99], v[70:71], v[82:83], v[98:99]
v_pk_fma_f32 v[100:101], v[72:73], v[82:83], v[100:101]
v_pk_fma_f32 v[86:87], v[56:57], v[84:85], v[86:87]
v_pk_fma_f32 v[88:89], v[58:59], v[84:85], v[88:89]
v_pk_fma_f32 v[90:91], v[60:61], v[84:85], v[90:91]
v_pk_fma_f32 v[92:93], v[62:63], v[84:85], v[92:93]
v_pk_fma_f32 v[94:95], v[64:65], v[84:85], v[94:95]
v_pk_fma_f32 v[96:97], v[66:67], v[84:85], v[96:97]
v_pk_fma_f32 v[98:99], v[68:69], v[84:85], v[98:99]
v_pk_fma_f32 v[100:101], v[70:71], v[84:85], v[100:101]
s_waitcnt lgkmcnt(0)
v_lshlrev_b32 v102, 16, v44
v_and_b32 v103, 0xffff0000, v44
v_pk_mul_f32 v[86:87], v[86:87], v[102:103]
v_lshlrev_b32 v104, 16, v45
v_and_b32 v105, 0xffff0000, v45
v_pk_mul_f32 v[88:89], v[88:89], v[104:105]
v_lshlrev_b32 v102, 16, v46
v_and_b32 v103, 0xffff0000, v46
v_pk_mul_f32 v[90:91], v[90:91], v[102:103]
v_lshlrev_b32 v104, 16, v47
v_and_b32 v105, 0xffff0000, v47
v_pk_mul_f32 v[92:93], v[92:93], v[104:105]
v_lshlrev_b32 v102, 16, v48
v_and_b32 v103, 0xffff0000, v48
v_pk_mul_f32 v[94:95], v[94:95], v[102:103]
v_lshlrev_b32 v104, 16, v49
v_and_b32 v105, 0xffff0000, v49
v_pk_mul_f32 v[96:97], v[96:97], v[104:105]
v_lshlrev_b32 v102, 16, v50
v_and_b32 v103, 0xffff0000, v50
v_pk_mul_f32 v[98:99], v[98:99], v[102:103]
v_lshlrev_b32 v104, 16, v51
v_and_b32 v105, 0xffff0000, v51
v_pk_mul_f32 v[100:101], v[100:101], v[104:105]
v_cvt_pk_bf16_f32 v108, v100, v98
v_cvt_pk_bf16_f32 v109, v96, v94
v_cvt_pk_bf16_f32 v110, v92, v90
v_cvt_pk_bf16_f32 v111, v88, v86
v_cvt_pk_bf16_f32 v112, v101, v99
v_cvt_pk_bf16_f32 v113, v97, v95
v_cvt_pk_bf16_f32 v114, v93, v91
v_cvt_pk_bf16_f32 v115, v89, v87
buffer_store_dwordx4 v[108:111], v28, s[44:47], 0 offen sc1
buffer_store_dwordx4 v[112:115], v29, s[44:47], 0 offen sc1
buffer_store_dwordx4 v[116:119], v121, s[44:47], 0 offen sc1
s_waitcnt vmcnt(11) lgkmcnt(0)
L_g1:
s_barrier
ds_read_b64_tr_b16 v[84:85], v14 offset:0
ds_read_b64_tr_b16 v[86:87], v14 offset:4096
ds_read_b128 v[116:119], v12 offset:0
ds_read_b128 v[120:123], v12 offset:2048
ds_read_b128 v[124:127], v12 offset:4096
ds_read_b128 v[128:131], v12 offset:6144
ds_read_b64_tr_b16 v[88:89], v15 offset:0
ds_read_b64_tr_b16 v[90:91], v15 offset:4096
ds_read_b64_tr_b16 v[92:93], v16 offset:0
ds_read_b64_tr_b16 v[94:95], v16 offset:4096
ds_read_b64_tr_b16 v[96:97], v17 offset:0
ds_read_b64_tr_b16 v[98:99], v17 offset:4096
s_waitcnt lgkmcnt(10)
v_mfma_f32_16x16x32_bf16 v[156:159], v[84:87], v[172:175], 0
s_waitcnt lgkmcnt(9)
ds_read_b64_tr_b16 v[100:101], v14 offset:8192
ds_read_b64_tr_b16 v[102:103], v14 offset:12288
s_add_u32 m0, s58, 32768
v_mfma_f32_16x16x32_bf16 v[20:23], v[84:87], v[116:119], 0
s_waitcnt lgkmcnt(10)
ds_read_b128 v[132:135], v13 offset:0
ds_read_b128 v[136:139], v13 offset:2048
s_nop 0
v_mfma_f32_16x16x32_bf16 v[36:39], v[84:87], v[120:123], 0
s_waitcnt lgkmcnt(11)
buffer_load_dwordx4 v4, s[4:7], s56 offen offset:0 lds
v_mfma_f32_16x16x32_bf16 v[52:55], v[84:87], v[124:127], 0
s_waitcnt lgkmcnt(10)
buffer_load_dwordx4 v5, s[4:7], s56 offen offset:1024 lds
v_mfma_f32_16x16x32_bf16 v[68:71], v[84:87], v[128:131], 0
s_waitcnt lgkmcnt(4)
buffer_load_dwordx4 v6, s[4:7], s56 offen offset:2048 lds
v_mfma_f32_16x16x32_bf16 v[160:163], v[88:91], v[172:175], 0
ds_read_b128 v[140:143], v13 offset:4096
v_add_u32 v245, 9216, v244
v_mfma_f32_16x16x32_bf16 v[24:27], v[88:91], v[116:119], 0
buffer_load_dwordx4 v7, s[4:7], s56 offen offset:3072 lds
v_mfma_f32_16x16x32_bf16 v[40:43], v[88:91], v[120:123], 0
ds_read_b128 v[144:147], v13 offset:6144
s_add_u32 m0, s59, 32768
v_mfma_f32_16x16x32_bf16 v[56:59], v[88:91], v[124:127], 0
ds_read_b64_tr_b16 v[104:105], v15 offset:8192
s_add_u32 s56, s56, 128
v_mfma_f32_16x16x32_bf16 v[72:75], v[88:91], v[128:131], 0
buffer_load_dwordx4 v8, s[28:31], s57 offen offset:0 lds
v_mfma_f32_16x16x32_bf16 v[28:31], v[92:95], v[116:119], 0
ds_read_b64_tr_b16 v[106:107], v15 offset:12288
v_add_u32 v246, 18432, v244
v_mfma_f32_16x16x32_bf16 v[44:47], v[92:95], v[120:123], 0
buffer_load_dwordx4 v9, s[28:31], s57 offen offset:1024 lds
v_mfma_f32_16x16x32_bf16 v[60:63], v[92:95], v[124:127], 0
ds_read_b64_tr_b16 v[108:109], v16 offset:8192
v_add_u32 v247, 27648, v244
v_mfma_f32_16x16x32_bf16 v[76:79], v[92:95], v[128:131], 0
ds_read_b64_tr_b16 v[110:111], v16 offset:12288
s_and_b32 s66, s50, 1
v_mfma_f32_16x16x32_bf16 v[32:35], v[96:99], v[116:119], 0
buffer_load_dwordx4 v10, s[28:31], s57 offen offset:2048 lds
v_mfma_f32_16x16x32_bf16 v[48:51], v[96:99], v[120:123], 0
ds_read_b64_tr_b16 v[112:113], v17 offset:8192
s_lshr_b32 s67, s50, 1
v_mfma_f32_16x16x32_bf16 v[64:67], v[96:99], v[124:127], 0
ds_read_b64_tr_b16 v[114:115], v17 offset:12288
s_lshl_b32 s70, s50, 12
v_mfma_f32_16x16x32_bf16 v[80:83], v[96:99], v[128:131], 0
s_waitcnt lgkmcnt(3)
buffer_load_dwordx4 v11, s[28:31], s57 offen offset:3072 lds
v_mfma_f32_16x16x32_bf16 v[156:159], v[100:103], v[172:175], v[156:159]
s_sub_u32 s57, s56, 1280
s_min_u32 s56, s56, s57
v_mfma_f32_16x16x32_bf16 v[20:23], v[100:103], v[132:135], v[20:23]
s_mul_i32 s57, s56, 1728
v_add_u32 v219, 98304, v19
v_mfma_f32_16x16x32_bf16 v[36:39], v[100:103], v[136:139], v[36:39]
s_waitcnt vmcnt(11) lgkmcnt(0)
s_barrier
ds_read_b64_tr_b16 v[84:85], v14 offset:16384
s_add_u32 m0, s58, 0
v_mfma_f32_16x16x32_bf16 v[52:55], v[100:103], v[140:143], v[52:55]
s_nop 0
ds_read_b64_tr_b16 v[86:87], v14 offset:20480
v_and_b32 v180, 15, v1
v_mfma_f32_16x16x32_bf16 v[68:71], v[100:103], v[144:147], v[68:71]
ds_read_b128 v[116:119], v12 offset:16384
v_lshrrev_b32 v181, 4, v1
v_mfma_f32_16x16x32_bf16 v[160:163], v[104:107], v[172:175], v[160:163]
buffer_load_dwordx4 v4, s[4:7], s56 offen offset:0 lds
v_mfma_f32_16x16x32_bf16 v[24:27], v[104:107], v[132:135], v[24:27]
ds_read_b128 v[120:123], v12 offset:18432
v_sub_u32 v182, 15, v180
v_mfma_f32_16x16x32_bf16 v[40:43], v[104:107], v[136:139], v[40:43]
buffer_load_dwordx4 v5, s[4:7], s56 offen offset:1024 lds
v_mfma_f32_16x16x32_bf16 v[56:59], v[104:107], v[140:143], v[56:59]
ds_read_b128 v[124:127], v12 offset:20480
v_and_b32 v214, 3, v182
v_mfma_f32_16x16x32_bf16 v[72:75], v[104:107], v[144:147], v[72:75]
buffer_load_dwordx4 v6, s[4:7], s56 offen offset:2048 lds
v_mfma_f32_16x16x32_bf16 v[28:31], v[108:111], v[132:135], v[28:31]
ds_read_b128 v[128:131], v12 offset:22528
v_mul_u32_u24 v214, 4160, v214
v_mfma_f32_16x16x32_bf16 v[44:47], v[108:111], v[136:139], v[44:47]
buffer_load_dwordx4 v7, s[4:7], s56 offen offset:3072 lds
v_mfma_f32_16x16x32_bf16 v[60:63], v[108:111], v[140:143], v[60:63]
ds_read_b64_tr_b16 v[88:89], v15 offset:16384
s_add_u32 m0, s59, 0
v_mfma_f32_16x16x32_bf16 v[76:79], v[108:111], v[144:147], v[76:79]
ds_read_b64_tr_b16 v[90:91], v15 offset:20480
s_add_u32 s56, s56, 128
v_mfma_f32_16x16x32_bf16 v[32:35], v[112:115], v[132:135], v[32:35]
buffer_load_dwordx4 v8, s[28:31], s57 offen offset:0 lds
v_mfma_f32_16x16x32_bf16 v[48:51], v[112:115], v[136:139], v[48:51]
buffer_load_dwordx4 v9, s[28:31], s57 offen offset:1024 lds
v_mfma_f32_16x16x32_bf16 v[64:67], v[112:115], v[140:143], v[64:67]
ds_read_b64_tr_b16 v[92:93], v16 offset:16384
v_lshrrev_b32 v183, 2, v182
v_mfma_f32_16x16x32_bf16 v[80:83], v[112:115], v[144:147], v[80:83]
s_waitcnt lgkmcnt(2)
buffer_load_dwordx4 v10, s[28:31], s57 offen offset:2048 lds
v_mfma_f32_16x16x32_bf16 v[156:159], v[84:87], v[172:175], v[156:159]
ds_read_b64_tr_b16 v[94:95], v16 offset:20480
ds_read_b64_tr_b16 v[96:97], v17 offset:16384
v_mfma_f32_16x16x32_bf16 v[20:23], v[84:87], v[116:119], v[20:23]
buffer_load_dwordx4 v11, s[28:31], s57 offen offset:3072 lds
ds_read_b64_tr_b16 v[98:99], v17 offset:20480
v_mfma_f32_16x16x32_bf16 v[36:39], v[84:87], v[120:123], v[36:39]
ds_read_b64_tr_b16 v[100:101], v14 offset:24576
ds_read_b64_tr_b16 v[102:103], v14 offset:28672
s_sub_u32 s57, s56, 1280
s_min_u32 s56, s56, s57
v_mfma_f32_16x16x32_bf16 v[52:55], v[84:87], v[124:127], v[52:55]
ds_read_b128 v[132:135], v13 offset:16384
ds_read_b128 v[136:139], v13 offset:18432
s_mul_i32 s57, s56, 1728
v_subrev_u32 v210, 8, v19
v_mfma_f32_16x16x32_bf16 v[68:71], v[84:87], v[128:131], v[68:71]
s_waitcnt lgkmcnt(7)
ds_read_b128 v[140:143], v13 offset:20480
ds_read_b128 v[144:147], v13 offset:22528
v_min_u32 v210, 2147483648, v210
v_mfma_f32_16x16x32_bf16 v[160:163], v[88:91], v[172:175], v[160:163]
buffer_load_dwordx2 v[192:193], v210, s[20:23], s72 offen
v_mfma_f32_16x16x32_bf16 v[24:27], v[88:91], v[116:119], v[24:27]
buffer_load_dwordx4 v[194:197], v19, s[20:23], s72 offen
v_mfma_f32_16x16x32_bf16 v[40:43], v[88:91], v[120:123], v[40:43]
buffer_load_dwordx2 v[198:199], v210, s[20:23], s73 offen
v_mfma_f32_16x16x32_bf16 v[56:59], v[88:91], v[124:127], v[56:59]
ds_read_b64_tr_b16 v[104:105], v15 offset:24576
v_lshlrev_b32 v183, 3, v183
v_mfma_f32_16x16x32_bf16 v[72:75], v[88:91], v[128:131], v[72:75]
s_waitcnt lgkmcnt(1)
buffer_load_dwordx4 v[200:203], v19, s[20:23], s73 offen
v_mfma_f32_16x16x32_bf16 v[28:31], v[92:95], v[116:119], v[28:31]
ds_read_b64_tr_b16 v[106:107], v15 offset:28672
v_sub_u32 v214, v214, v183
v_mfma_f32_16x16x32_bf16 v[44:47], v[92:95], v[120:123], v[44:47]
buffer_load_dwordx2 v[204:205], v210, s[20:23], s74 offen
v_mfma_f32_16x16x32_bf16 v[60:63], v[92:95], v[124:127], v[60:63]
ds_read_b64_tr_b16 v[108:109], v16 offset:24576
v_lshl_add_u32 v214, v181, 4, v214
v_mfma_f32_16x16x32_bf16 v[76:79], v[92:95], v[128:131], v[76:79]
ds_read_b64_tr_b16 v[110:111], v16 offset:28672
v_lshlrev_b32 v215, 5, v180
v_mfma_f32_16x16x32_bf16 v[32:35], v[96:99], v[116:119], v[32:35]
buffer_load_dwordx4 v[206:209], v19, s[20:23], s74 offen
v_mfma_f32_16x16x32_bf16 v[48:51], v[96:99], v[120:123], v[48:51]
ds_read_b64_tr_b16 v[112:113], v17 offset:24576
v_sub_u32 v215, 17088, v215
v_mfma_f32_16x16x32_bf16 v[64:67], v[96:99], v[124:127], v[64:67]
ds_read_b64_tr_b16 v[114:115], v17 offset:28672
v_lshl_add_u32 v215, v181, 4, v215
v_mfma_f32_16x16x32_bf16 v[80:83], v[96:99], v[128:131], v[80:83]
buffer_load_ushort v211, v239, s[20:23], 0 offen
v_mfma_f32_16x16x32_bf16 v[156:159], v[100:103], v[172:175], v[156:159]
v_lshrrev_b32 v239, 11, v239
s_mul_i32 s3, s67, 21248
v_mfma_f32_16x16x32_bf16 v[20:23], v[100:103], v[132:135], v[20:23]
buffer_load_ushort v253, v239, s[24:27], 0 offen
v_mfma_f32_16x16x32_bf16 v[36:39], v[100:103], v[136:139], v[36:39]
s_waitcnt vmcnt(16) lgkmcnt(0)
s_barrier
s_load_dword s63, s[40:41], 0
ds_read_b64_tr_b16 v[84:85], v14 offset:32768
s_add_u32 m0, s58, 16384
v_mfma_f32_16x16x32_bf16 v[52:55], v[100:103], v[140:143], v[52:55]
s_nop 0
ds_read_b64_tr_b16 v[86:87], v14 offset:36864
s_lshl_b32 s62, s66, 8
v_mfma_f32_16x16x32_bf16 v[68:71], v[100:103], v[144:147], v[68:71]
ds_read_b128 v[116:119], v12 offset:32768
s_add_u32 s3, s3, s62
v_mfma_f32_16x16x32_bf16 v[160:163], v[104:107], v[172:175], v[160:163]
buffer_load_dwordx4 v4, s[4:7], s56 offen offset:0 lds
v_mfma_f32_16x16x32_bf16 v[24:27], v[104:107], v[132:135], v[24:27]
ds_read_b128 v[120:123], v12 offset:34816
s_add_u32 s3, s3, 98336
v_mfma_f32_16x16x32_bf16 v[40:43], v[104:107], v[136:139], v[40:43]
ds_read_b128 v[124:127], v12 offset:36864
v_add_u32 v212, s3, v214
v_mfma_f32_16x16x32_bf16 v[56:59], v[104:107], v[140:143], v[56:59]
ds_read_b128 v[128:131], v12 offset:38912
v_add_u32 v213, s3, v215
v_mfma_f32_16x16x32_bf16 v[72:75], v[104:107], v[144:147], v[72:75]
buffer_load_dwordx4 v5, s[4:7], s56 offen offset:1024 lds
v_mfma_f32_16x16x32_bf16 v[28:31], v[108:111], v[132:135], v[28:31]
ds_read_b64_tr_b16 v[88:89], v15 offset:32768
s_lshl_b32 s3, s50, 7
v_mfma_f32_16x16x32_bf16 v[44:47], v[108:111], v[136:139], v[44:47]
ds_read_b64_tr_b16 v[90:91], v15 offset:36864
s_add_u32 s3, s3, 140832
v_mfma_f32_16x16x32_bf16 v[60:63], v[108:111], v[140:143], v[60:63]
ds_read_b64_tr_b16 v[92:93], v16 offset:32768
v_add_u32 v214, s3, v214
v_mfma_f32_16x16x32_bf16 v[76:79], v[108:111], v[144:147], v[76:79]
buffer_load_dwordx4 v6, s[4:7], s56 offen offset:2048 lds
v_mfma_f32_16x16x32_bf16 v[32:35], v[112:115], v[132:135], v[32:35]
ds_read_b64_tr_b16 v[94:95], v16 offset:36864
v_add_u32 v215, s3, v215
v_mfma_f32_16x16x32_bf16 v[48:51], v[112:115], v[136:139], v[48:51]
ds_read_b64_tr_b16 v[96:97], v17 offset:32768
s_add_u32 s3, s70, 0
v_mfma_f32_16x16x32_bf16 v[64:67], v[112:115], v[140:143], v[64:67]
ds_read_b64_tr_b16 v[98:99], v17 offset:36864
v_add_u32 v216, s3, v18
v_mfma_f32_16x16x32_bf16 v[80:83], v[112:115], v[144:147], v[80:83]
s_waitcnt lgkmcnt(3)
buffer_load_dwordx4 v7, s[4:7], s56 offen offset:3072 lds
v_mfma_f32_16x16x32_bf16 v[156:159], v[84:87], v[172:175], v[156:159]
ds_read_b64_tr_b16 v[100:101], v14 offset:40960
s_add_u32 m0, s59, 16384
v_mfma_f32_16x16x32_bf16 v[20:23], v[84:87], v[116:119], v[20:23]
ds_read_b64_tr_b16 v[102:103], v14 offset:45056
s_add_u32 s56, s56, 128
v_mfma_f32_16x16x32_bf16 v[36:39], v[84:87], v[120:123], v[36:39]
ds_read_b128 v[132:135], v13 offset:32768
s_lshl_b32 s3, s50, 10
v_mfma_f32_16x16x32_bf16 v[52:55], v[84:87], v[124:127], v[52:55]
buffer_load_dwordx4 v8, s[28:31], s57 offen offset:0 lds
v_mfma_f32_16x16x32_bf16 v[68:71], v[84:87], v[128:131], v[68:71]
ds_read_b128 v[136:139], v13 offset:34816
s_add_u32 s3, s3, 0
v_mfma_f32_16x16x32_bf16 v[160:163], v[88:91], v[172:175], v[160:163]
ds_read_b128 v[140:143], v13 offset:36864
v_add_u32 v220, s3, v18
v_mfma_f32_16x16x32_bf16 v[24:27], v[88:91], v[116:119], v[24:27]
ds_read_b128 v[144:147], v13 offset:38912
v_lshlrev_b32 v221, 5, v180
v_mfma_f32_16x16x32_bf16 v[40:43], v[88:91], v[120:123], v[40:43]
buffer_load_dwordx4 v9, s[28:31], s57 offen offset:1024 lds
v_mfma_f32_16x16x32_bf16 v[56:59], v[88:91], v[124:127], v[56:59]
ds_read_b64_tr_b16 v[104:105], v15 offset:40960
v_lshl_add_u32 v221, v181, 3, v221
v_mfma_f32_16x16x32_bf16 v[72:75], v[88:91], v[128:131], v[72:75]
s_waitcnt lgkmcnt(3)
ds_read_b64_tr_b16 v[106:107], v15 offset:45056
s_lshl_b32 s3, s67, 2
v_mfma_f32_16x16x32_bf16 v[28:31], v[92:95], v[116:119], v[28:31]
ds_read_b64_tr_b16 v[108:109], v16 offset:40960
s_bitcmp1_b32 s49, 0
s_cselect_b32 s3, 2, s3
v_mfma_f32_16x16x32_bf16 v[44:47], v[92:95], v[120:123], v[44:47]
buffer_load_dwordx4 v10, s[28:31], s57 offen offset:2048 lds
v_mfma_f32_16x16x32_bf16 v[60:63], v[92:95], v[124:127], v[60:63]
ds_read_b64_tr_b16 v[110:111], v16 offset:45056
s_add_u32 s3, s3, s50
v_mfma_f32_16x16x32_bf16 v[76:79], v[92:95], v[128:131], v[76:79]
ds_read_b64_tr_b16 v[112:113], v17 offset:40960
s_lshl_b32 s3, s3, 9
v_mfma_f32_16x16x32_bf16 v[32:35], v[96:99], v[116:119], v[32:35]
ds_read_b64_tr_b16 v[114:115], v17 offset:45056
s_add_u32 s3, s3, s74
v_mfma_f32_16x16x32_bf16 v[48:51], v[96:99], v[120:123], v[48:51]
buffer_load_dwordx4 v11, s[28:31], s57 offen offset:3072 lds
v_mfma_f32_16x16x32_bf16 v[64:67], v[96:99], v[124:127], v[64:67]
s_sub_u32 s57, s56, 1280
s_min_u32 s56, s56, s57
v_mfma_f32_16x16x32_bf16 v[80:83], v[96:99], v[128:131], v[80:83]
s_mul_i32 s57, s56, 1728
s_add_u32 s3, s3, 2621440
v_mfma_f32_16x16x32_bf16 v[156:159], v[100:103], v[172:175], v[156:159]
v_add_u32 v221, s3, v221
s_lshr_b32 s3, s55, 6
v_mfma_f32_16x16x32_bf16 v[20:23], v[100:103], v[132:135], v[20:23]
s_lshl_b32 s3, s3, 7
s_add_u32 s66, s3, 5291008
v_mfma_f32_16x16x32_bf16 v[36:39], v[100:103], v[136:139], v[36:39]
s_waitcnt vmcnt(16) lgkmcnt(0)
s_barrier
s_cmp_eq_u32 s63, 0
s_cbranch_scc1 LS_iG
LR_iG:
buffer_atomic_add v3, v242, s[44:47], 0 offen sc1
ds_read_b64_tr_b16 v[84:85], v14 offset:0
s_add_u32 m0, s58, 32768
v_mfma_f32_16x16x32_bf16 v[52:55], v[100:103], v[140:143], v[52:55]
s_nop 0
ds_read_b64_tr_b16 v[86:87], v14 offset:4096
s_add_u32 s3, s55, 4
v_mfma_f32_16x16x32_bf16 v[68:71], v[100:103], v[144:147], v[68:71]
ds_read_b128 v[116:119], v12 offset:0
s_lshr_b32 s3, s3, 6
v_mfma_f32_16x16x32_bf16 v[160:163], v[104:107], v[172:175], v[160:163]
buffer_load_dwordx4 v4, s[4:7], s56 offen offset:0 lds
v_mfma_f32_16x16x32_bf16 v[24:27], v[104:107], v[132:135], v[24:27]
ds_read_b128 v[120:123], v12 offset:2048
s_lshl_b32 s3, s3, 7
v_mfma_f32_16x16x32_bf16 v[40:43], v[104:107], v[136:139], v[40:43]
ds_read_b128 v[124:127], v12 offset:4096
s_add_u32 s67, s3, 5291008
v_mfma_f32_16x16x32_bf16 v[56:59], v[104:107], v[140:143], v[56:59]
ds_read_b128 v[128:131], v12 offset:6144
s_sub_u32 s62, s67, s66
v_mfma_f32_16x16x32_bf16 v[72:75], v[104:107], v[144:147], v[72:75]
buffer_load_dwordx4 v5, s[4:7], s56 offen offset:1024 lds
v_mfma_f32_16x16x32_bf16 v[28:31], v[108:111], v[132:135], v[28:31]
ds_read_b64_tr_b16 v[88:89], v15 offset:0
v_lshrrev_b32 v183, 5, v1
v_mfma_f32_16x16x32_bf16 v[44:47], v[108:111], v[136:139], v[44:47]
ds_read_b64_tr_b16 v[90:91], v15 offset:4096
v_mul_u32_u24 v182, s62, v183
v_mfma_f32_16x16x32_bf16 v[60:63], v[108:111], v[140:143], v[60:63]
ds_read_b64_tr_b16 v[92:93], v16 offset:0
v_add_u32 v238, s66, v182
v_mfma_f32_16x16x32_bf16 v[76:79], v[108:111], v[144:147], v[76:79]
buffer_load_dwordx4 v6, s[4:7], s56 offen offset:2048 lds
v_mfma_f32_16x16x32_bf16 v[32:35], v[112:115], v[132:135], v[32:35]
ds_read_b64_tr_b16 v[94:95], v16 offset:4096
s_mul_i32 s71, s60, 40960
v_mfma_f32_16x16x32_bf16 v[48:51], v[112:115], v[136:139], v[48:51]
ds_read_b64_tr_b16 v[96:97], v17 offset:0
s_mov_b32 s68, 0
v_mfma_f32_16x16x32_bf16 v[64:67], v[112:115], v[140:143], v[64:67]
ds_read_b64_tr_b16 v[98:99], v17 offset:4096
s_mul_i32 s3, s54, 56
v_mfma_f32_16x16x32_bf16 v[80:83], v[112:115], v[144:147], v[80:83]
s_waitcnt lgkmcnt(3)
buffer_load_dwordx4 v7, s[4:7], s56 offen offset:3072 lds
v_mfma_f32_16x16x32_bf16 v[156:159], v[84:87], v[172:175], v[156:159]
ds_read_b64_tr_b16 v[100:101], v14 offset:8192
s_add_u32 m0, s59, 32768
v_mfma_f32_16x16x32_bf16 v[20:23], v[84:87], v[116:119], v[20:23]
ds_read_b64_tr_b16 v[102:103], v14 offset:12288
s_add_u32 s56, s56, 128
v_mfma_f32_16x16x32_bf16 v[36:39], v[84:87], v[120:123], v[36:39]
ds_read_b128 v[132:135], v13 offset:0
s_mul_i32 s62, s75, 28
v_mfma_f32_16x16x32_bf16 v[52:55], v[84:87], v[124:127], v[52:55]
buffer_load_dwordx4 v8, s[28:31], s57 offen offset:0 lds
v_mfma_f32_16x16x32_bf16 v[68:71], v[84:87], v[128:131], v[68:71]
ds_read_b128 v[136:139], v13 offset:2048
s_add_u32 s3, s3, s62
v_mfma_f32_16x16x32_bf16 v[160:163], v[88:91], v[172:175], v[160:163]
ds_read_b128 v[140:143], v13 offset:4096
s_mul_i32 s62, s50, 7
v_mfma_f32_16x16x32_bf16 v[24:27], v[88:91], v[116:119], v[24:27]
ds_read_b128 v[144:147], v13 offset:6144
s_add_u32 s3, s3, s62
v_mfma_f32_16x16x32_bf16 v[40:43], v[88:91], v[120:123], v[40:43]
buffer_load_dwordx4 v9, s[28:31], s57 offen offset:1024 lds
v_mfma_f32_16x16x32_bf16 v[56:59], v[88:91], v[124:127], v[56:59]
ds_read_b64_tr_b16 v[104:105], v15 offset:8192
s_lshl_b32 s3, s3, 10
v_mfma_f32_16x16x32_bf16 v[72:75], v[88:91], v[128:131], v[72:75]
s_waitcnt lgkmcnt(3)
ds_read_b64_tr_b16 v[106:107], v15 offset:12288
s_add_u32 s17, s3, 16777216
v_mfma_f32_16x16x32_bf16 v[28:31], v[92:95], v[116:119], v[28:31]
ds_read_b64_tr_b16 v[108:109], v16 offset:8192
v_bfe_u32 v180, v1, 3, 2
v_mfma_f32_16x16x32_bf16 v[44:47], v[92:95], v[120:123], v[44:47]
buffer_load_dwordx4 v10, s[28:31], s57 offen offset:2048 lds
v_mfma_f32_16x16x32_bf16 v[60:63], v[92:95], v[124:127], v[60:63]
ds_read_b64_tr_b16 v[110:111], v16 offset:12288
v_lshlrev_b32 v180, 5, v180
v_mfma_f32_16x16x32_bf16 v[76:79], v[92:95], v[128:131], v[76:79]
ds_read_b64_tr_b16 v[112:113], v17 offset:8192
v_lshrrev_b32 v249, 2, v1
v_mfma_f32_16x16x32_bf16 v[32:35], v[96:99], v[116:119], v[32:35]
ds_read_b64_tr_b16 v[114:115], v17 offset:12288
v_lshl_add_u32 v180, v249, 7, v180
v_mfma_f32_16x16x32_bf16 v[48:51], v[96:99], v[120:123], v[48:51]
buffer_load_dwordx4 v11, s[28:31], s57 offen offset:3072 lds
v_mfma_f32_16x16x32_bf16 v[64:67], v[96:99], v[124:127], v[64:67]
s_sub_u32 s57, s56, 1280
s_min_u32 s56, s56, s57
v_mfma_f32_16x16x32_bf16 v[80:83], v[96:99], v[128:131], v[80:83]
s_mul_i32 s57, s56, 1728
v_and_b32 v249, 3, v1
v_mfma_f32_16x16x32_bf16 v[156:159], v[100:103], v[172:175], v[156:159]
v_lshl_add_u32 v180, v249, 3, v180
s_add_u32 s3, s70, 16384
v_mfma_f32_16x16x32_bf16 v[20:23], v[100:103], v[132:135], v[20:23]
v_add_u32 v248, s3, v180
v_xor_b32 v249, 32, v248
v_mfma_f32_16x16x32_bf16 v[36:39], v[100:103], v[136:139], v[36:39]
s_waitcnt vmcnt(9) lgkmcnt(0)
s_barrier
ds_read_b64_tr_b16 v[84:85], v14 offset:16384
s_add_u32 m0, s58, 0
v_mfma_f32_16x16x32_bf16 v[52:55], v[100:103], v[140:143], v[52:55]
s_nop 0
ds_read_b64_tr_b16 v[86:87], v14 offset:20480
v_xor_b32 v236, 64, v248
v_mfma_f32_16x16x32_bf16 v[68:71], v[100:103], v[144:147], v[68:71]
ds_read_b128 v[116:119], v12 offset:16384
v_xor_b32 v243, 96, v248
v_mfma_f32_16x16x32_bf16 v[160:163], v[104:107], v[172:175], v[160:163]
buffer_load_dwordx4 v4, s[4:7], s56 offen offset:0 lds
v_mfma_f32_16x16x32_bf16 v[24:27], v[104:107], v[132:135], v[24:27]
ds_read_b128 v[120:123], v12 offset:18432
s_lshl_b32 s3, s51, 1
v_mfma_f32_16x16x32_bf16 v[40:43], v[104:107], v[136:139], v[40:43]
ds_read_b128 v[124:127], v12 offset:20480
s_add_u32 s3, s3, s75
v_mfma_f32_16x16x32_bf16 v[56:59], v[104:107], v[140:143], v[56:59]
ds_read_b128 v[128:131], v12 offset:22528
s_lshl_b32 s3, s3, 7
v_mfma_f32_16x16x32_bf16 v[72:75], v[104:107], v[144:147], v[72:75]
buffer_load_dwordx4 v5, s[4:7], s56 offen offset:1024 lds
v_mfma_f32_16x16x32_bf16 v[28:31], v[108:111], v[132:135], v[28:31]
ds_read_b64_tr_b16 v[88:89], v15 offset:16384
s_add_u32 s3, s3, 5275648
v_mfma_f32_16x16x32_bf16 v[44:47], v[108:111], v[136:139], v[44:47]
ds_read_b64_tr_b16 v[90:91], v15 offset:20480
v_or_b32 v254, s3, v2
v_mfma_f32_16x16x32_bf16 v[60:63], v[108:111], v[140:143], v[60:63]
ds_read_b64_tr_b16 v[92:93], v16 offset:16384
s_lshr_b32 s65, s50, 1
v_mfma_f32_16x16x32_bf16 v[76:79], v[108:111], v[144:147], v[76:79]
buffer_load_dwordx4 v6, s[4:7], s56 offen offset:2048 lds
v_mfma_f32_16x16x32_bf16 v[32:35], v[112:115], v[132:135], v[32:35]
ds_read_b64_tr_b16 v[94:95], v16 offset:20480
s_lshl_b32 s3, s65, 2
v_mfma_f32_16x16x32_bf16 v[48:51], v[112:115], v[136:139], v[48:51]
ds_read_b64_tr_b16 v[96:97], v17 offset:16384
s_lshl_b32 s62, s51, 3
v_mfma_f32_16x16x32_bf16 v[64:67], v[112:115], v[140:143], v[64:67]
ds_read_b64_tr_b16 v[98:99], v17 offset:20480
s_add_u32 s3, s3, s62
v_mfma_f32_16x16x32_bf16 v[80:83], v[112:115], v[144:147], v[80:83]
s_waitcnt lgkmcnt(3)
buffer_load_dwordx4 v7, s[4:7], s56 offen offset:3072 lds
v_mfma_f32_16x16x32_bf16 v[156:159], v[84:87], v[172:175], v[156:159]
ds_read_b64_tr_b16 v[100:101], v14 offset:24576
s_add_u32 m0, s59, 0
v_mfma_f32_16x16x32_bf16 v[20:23], v[84:87], v[116:119], v[20:23]
ds_read_b64_tr_b16 v[102:103], v14 offset:28672
s_add_u32 s56, s56, 128
v_mfma_f32_16x16x32_bf16 v[36:39], v[84:87], v[120:123], v[36:39]
ds_read_b128 v[132:135], v13 offset:16384
s_mul_i32 s3, s3, 56
v_mfma_f32_16x16x32_bf16 v[52:55], v[84:87], v[124:127], v[52:55]
buffer_load_dwordx4 v8, s[28:31], s57 offen offset:0 lds
v_mfma_f32_16x16x32_bf16 v[68:71], v[84:87], v[128:131], v[68:71]
ds_read_b128 v[136:139], v13 offset:18432
s_lshl_b32 s62, s52, 2
v_mfma_f32_16x16x32_bf16 v[160:163], v[88:91], v[172:175], v[160:163]
ds_read_b128 v[140:143], v13 offset:20480
s_add_u32 s3, s3, s62
v_mfma_f32_16x16x32_bf16 v[24:27], v[88:91], v[116:119], v[24:27]
ds_read_b128 v[144:147], v13 offset:22528
s_and_b32 s62, s50, 1
v_mfma_f32_16x16x32_bf16 v[40:43], v[88:91], v[120:123], v[40:43]
buffer_load_dwordx4 v9, s[28:31], s57 offen offset:1024 lds
v_mfma_f32_16x16x32_bf16 v[56:59], v[88:91], v[124:127], v[56:59]
ds_read_b64_tr_b16 v[104:105], v15 offset:24576
s_lshl_b32 s62, s62, 1
v_mfma_f32_16x16x32_bf16 v[72:75], v[88:91], v[128:131], v[72:75]
s_waitcnt lgkmcnt(3)
ds_read_b64_tr_b16 v[106:107], v15 offset:28672
s_add_u32 s3, s3, s62
v_mfma_f32_16x16x32_bf16 v[28:31], v[92:95], v[116:119], v[28:31]
ds_read_b64_tr_b16 v[108:109], v16 offset:24576
s_add_u32 s3, s3, s65
v_mfma_f32_16x16x32_bf16 v[44:47], v[92:95], v[120:123], v[44:47]
buffer_load_dwordx4 v10, s[28:31], s57 offen offset:2048 lds
v_mfma_f32_16x16x32_bf16 v[60:63], v[92:95], v[124:127], v[60:63]
ds_read_b64_tr_b16 v[110:111], v16 offset:28672
s_lshl_b32 s3, s3, 10
v_mfma_f32_16x16x32_bf16 v[76:79], v[92:95], v[128:131], v[76:79]
ds_read_b64_tr_b16 v[112:113], v17 offset:24576
s_add_u32 s64, s3, 6291456
v_mfma_f32_16x16x32_bf16 v[32:35], v[96:99], v[116:119], v[32:35]
ds_read_b64_tr_b16 v[114:115], v17 offset:28672
s_xor_b32 s65, s64, 1024
v_mfma_f32_16x16x32_bf16 v[48:51], v[96:99], v[120:123], v[48:51]
buffer_load_dwordx4 v11, s[28:31], s57 offen offset:3072 lds
v_mfma_f32_16x16x32_bf16 v[64:67], v[96:99], v[124:127], v[64:67]
s_sub_u32 s57, s56, 1280
s_min_u32 s56, s56, s57
v_mfma_f32_16x16x32_bf16 v[80:83], v[96:99], v[128:131], v[80:83]
s_mul_i32 s57, s56, 1728
v_mov_b32 v228, 0
v_mfma_f32_16x16x32_bf16 v[156:159], v[100:103], v[172:175], v[156:159]
v_mov_b32 v229, 0
v_mov_b32 v230, 0
v_mfma_f32_16x16x32_bf16 v[20:23], v[100:103], v[132:135], v[20:23]
v_mov_b32 v231, 0
v_min_u32 v184, 39, v1
v_mfma_f32_16x16x32_bf16 v[36:39], v[100:103], v[136:139], v[36:39]
s_waitcnt vmcnt(8) lgkmcnt(0)
s_barrier
ds_read_b64_tr_b16 v[84:85], v14 offset:32768
s_add_u32 m0, s58, 16384
v_mfma_f32_16x16x32_bf16 v[52:55], v[100:103], v[140:143], v[52:55]
s_nop 0
ds_read_b64_tr_b16 v[86:87], v14 offset:36864
v_lshrrev_b32 v185, 5, v184
v_mfma_f32_16x16x32_bf16 v[68:71], v[100:103], v[144:147], v[68:71]
ds_read_b128 v[116:119], v12 offset:32768
v_bfe_u32 v186, v184, 1, 2
v_mfma_f32_16x16x32_bf16 v[160:163], v[104:107], v[172:175], v[160:163]
buffer_load_dwordx4 v4, s[4:7], s56 offen offset:0 lds
v_mfma_f32_16x16x32_bf16 v[24:27], v[104:107], v[132:135], v[24:27]
ds_read_b128 v[120:123], v12 offset:34816
v_mul_u32_u24 v186, 4128, v186
v_mfma_f32_16x16x32_bf16 v[40:43], v[104:107], v[136:139], v[40:43]
ds_read_b128 v[124:127], v12 offset:36864
v_subrev_u32 v186, 21248, v186
v_mfma_f32_16x16x32_bf16 v[56:59], v[104:107], v[140:143], v[56:59]
ds_read_b128 v[128:131], v12 offset:38912
v_mul_i32_i24 v186, v185, v186
v_mfma_f32_16x16x32_bf16 v[72:75], v[104:107], v[144:147], v[72:75]
buffer_load_dwordx4 v5, s[4:7], s56 offen offset:1024 lds
v_mfma_f32_16x16x32_bf16 v[28:31], v[108:111], v[132:135], v[28:31]
ds_read_b64_tr_b16 v[88:89], v15 offset:32768
v_lshl_add_u32 v232, v184, 4, v186
v_mfma_f32_16x16x32_bf16 v[44:47], v[108:111], v[136:139], v[44:47]
ds_read_b64_tr_b16 v[90:91], v15 offset:36864
s_min_u32 s3, s50, 2
v_mfma_f32_16x16x32_bf16 v[60:63], v[108:111], v[140:143], v[60:63]
ds_read_b64_tr_b16 v[92:93], v16 offset:32768
s_mul_i32 s3, s3, 21248
v_mfma_f32_16x16x32_bf16 v[76:79], v[108:111], v[144:147], v[76:79]
buffer_load_dwordx4 v6, s[4:7], s56 offen offset:2048 lds
v_mfma_f32_16x16x32_bf16 v[32:35], v[112:115], v[132:135], v[32:35]
ds_read_b64_tr_b16 v[94:95], v16 offset:36864
s_add_u32 s3, s3, 119040
v_mfma_f32_16x16x32_bf16 v[48:51], v[112:115], v[136:139], v[48:51]
ds_read_b64_tr_b16 v[96:97], v17 offset:32768
v_add_u32 v232, s3, v232
v_mfma_f32_16x16x32_bf16 v[64:67], v[112:115], v[140:143], v[64:67]
ds_read_b64_tr_b16 v[98:99], v17 offset:36864
v_cmp_eq_u32 vcc, 1, v0
v_and_b32 v180, 0x7fffffff, v241
s_nop 0
v_cndmask_b32 v234, v234, v180, vcc
v_mfma_f32_16x16x32_bf16 v[80:83], v[112:115], v[144:147], v[80:83]
s_waitcnt lgkmcnt(3)
buffer_load_dwordx4 v7, s[4:7], s56 offen offset:3072 lds
v_mfma_f32_16x16x32_bf16 v[156:159], v[84:87], v[172:175], v[156:159]
ds_read_b64_tr_b16 v[100:101], v14 offset:40960
s_add_u32 m0, s59, 16384
v_mfma_f32_16x16x32_bf16 v[20:23], v[84:87], v[116:119], v[20:23]
ds_read_b64_tr_b16 v[102:103], v14 offset:45056
s_add_u32 s56, s56, 128
v_mfma_f32_16x16x32_bf16 v[36:39], v[84:87], v[120:123], v[36:39]
ds_read_b128 v[132:135], v13 offset:32768
v_alignbit_b32 v180, v194, v193, 16
v_mfma_f32_16x16x32_bf16 v[52:55], v[84:87], v[124:127], v[52:55]
buffer_load_dwordx4 v8, s[28:31], s57 offen offset:0 lds
v_mfma_f32_16x16x32_bf16 v[68:71], v[84:87], v[128:131], v[68:71]
ds_read_b128 v[136:139], v13 offset:34816
v_alignbit_b32 v181, v195, v194, 16
v_mfma_f32_16x16x32_bf16 v[160:163], v[88:91], v[172:175], v[160:163]
ds_read_b128 v[140:143], v13 offset:36864
v_alignbit_b32 v182, v196, v195, 16
v_mfma_f32_16x16x32_bf16 v[24:27], v[88:91], v[116:119], v[24:27]
ds_read_b128 v[144:147], v13 offset:38912
v_alignbit_b32 v183, v197, v196, 16
v_mfma_f32_16x16x32_bf16 v[40:43], v[88:91], v[120:123], v[40:43]
buffer_load_dwordx4 v9, s[28:31], s57 offen offset:1024 lds
v_mfma_f32_16x16x32_bf16 v[56:59], v[88:91], v[124:127], v[56:59]
ds_read_b64_tr_b16 v[104:105], v15 offset:40960
v_accvgpr_write_b32 a240, v193
v_mfma_f32_16x16x32_bf16 v[72:75], v[88:91], v[128:131], v[72:75]
s_waitcnt lgkmcnt(3)
ds_read_b64_tr_b16 v[106:107], v15 offset:45056
v_accvgpr_write_b32 a241, v194
v_mfma_f32_16x16x32_bf16 v[28:31], v[92:95], v[116:119], v[28:31]
ds_read_b64_tr_b16 v[108:109], v16 offset:40960
v_accvgpr_write_b32 a242, v195
v_mfma_f32_16x16x32_bf16 v[44:47], v[92:95], v[120:123], v[44:47]
buffer_load_dwordx4 v10, s[28:31], s57 offen offset:2048 lds
v_mfma_f32_16x16x32_bf16 v[60:63], v[92:95], v[124:127], v[60:63]
ds_read_b64_tr_b16 v[110:111], v16 offset:45056
v_accvgpr_write_b32 a243, v196
v_mfma_f32_16x16x32_bf16 v[76:79], v[92:95], v[128:131], v[76:79]
ds_read_b64_tr_b16 v[112:113], v17 offset:40960
v_alignbit_b32 v184, v193, v192, 16
v_mfma_f32_16x16x32_bf16 v[32:35], v[96:99], v[116:119], v[32:35]
ds_read_b64_tr_b16 v[114:115], v17 offset:45056
v_alignbit_b32 v185, v194, v193, 16
v_mfma_f32_16x16x32_bf16 v[48:51], v[96:99], v[120:123], v[48:51]
buffer_load_dwordx4 v11, s[28:31], s57 offen offset:3072 lds
v_mfma_f32_16x16x32_bf16 v[64:67], v[96:99], v[124:127], v[64:67]
s_sub_u32 s57, s56, 1280
s_min_u32 s56, s56, s57
v_mfma_f32_16x16x32_bf16 v[80:83], v[96:99], v[128:131], v[80:83]
s_mul_i32 s57, s56, 1728
v_alignbit_b32 v186, v195, v194, 16
v_mfma_f32_16x16x32_bf16 v[156:159], v[100:103], v[172:175], v[156:159]
v_alignbit_b32 v187, v196, v195, 16
v_alignbit_b32 v188, v200, v199, 16
v_mfma_f32_16x16x32_bf16 v[20:23], v[100:103], v[132:135], v[20:23]
v_alignbit_b32 v189, v201, v200, 16
v_alignbit_b32 v190, v202, v201, 16
v_mfma_f32_16x16x32_bf16 v[36:39], v[100:103], v[136:139], v[36:39]
s_waitcnt vmcnt(8) lgkmcnt(0)
s_barrier
ds_read_b64_tr_b16 v[84:85], v14 offset:0
s_add_u32 m0, s58, 32768
v_mfma_f32_16x16x32_bf16 v[52:55], v[100:103], v[140:143], v[52:55]
s_nop 0
ds_read_b64_tr_b16 v[86:87], v14 offset:4096
v_alignbit_b32 v191, v203, v202, 16
v_mfma_f32_16x16x32_bf16 v[68:71], v[100:103], v[144:147], v[68:71]
ds_read_b128 v[116:119], v12 offset:0
v_accvgpr_write_b32 a244, v199
v_mfma_f32_16x16x32_bf16 v[160:163], v[104:107], v[172:175], v[160:163]
buffer_load_dwordx4 v4, s[4:7], s56 offen offset:0 lds
v_mfma_f32_16x16x32_bf16 v[24:27], v[104:107], v[132:135], v[24:27]
ds_read_b128 v[120:123], v12 offset:2048
v_accvgpr_write_b32 a245, v200
v_mfma_f32_16x16x32_bf16 v[40:43], v[104:107], v[136:139], v[40:43]
ds_read_b128 v[124:127], v12 offset:4096
v_accvgpr_write_b32 a246, v201
v_mfma_f32_16x16x32_bf16 v[56:59], v[104:107], v[140:143], v[56:59]
ds_read_b128 v[128:131], v12 offset:6144
v_accvgpr_write_b32 a247, v202
v_mfma_f32_16x16x32_bf16 v[72:75], v[104:107], v[144:147], v[72:75]
buffer_load_dwordx4 v5, s[4:7], s56 offen offset:1024 lds
v_mfma_f32_16x16x32_bf16 v[28:31], v[108:111], v[132:135], v[28:31]
ds_read_b64_tr_b16 v[88:89], v15 offset:0
v_alignbit_b32 v164, v199, v198, 16
v_mfma_f32_16x16x32_bf16 v[44:47], v[108:111], v[136:139], v[44:47]
ds_read_b64_tr_b16 v[90:91], v15 offset:4096
v_alignbit_b32 v165, v200, v199, 16
v_mfma_f32_16x16x32_bf16 v[60:63], v[108:111], v[140:143], v[60:63]
ds_read_b64_tr_b16 v[92:93], v16 offset:0
v_alignbit_b32 v166, v201, v200, 16
v_mfma_f32_16x16x32_bf16 v[76:79], v[108:111], v[144:147], v[76:79]
buffer_load_dwordx4 v6, s[4:7], s56 offen offset:2048 lds
v_mfma_f32_16x16x32_bf16 v[32:35], v[112:115], v[132:135], v[32:35]
ds_read_b64_tr_b16 v[94:95], v16 offset:4096
v_alignbit_b32 v167, v202, v201, 16
v_mfma_f32_16x16x32_bf16 v[48:51], v[112:115], v[136:139], v[48:51]
ds_read_b64_tr_b16 v[96:97], v17 offset:0
v_alignbit_b32 v168, v206, v205, 16
v_mfma_f32_16x16x32_bf16 v[64:67], v[112:115], v[140:143], v[64:67]
ds_read_b64_tr_b16 v[98:99], v17 offset:4096
v_alignbit_b32 v169, v207, v206, 16
v_mfma_f32_16x16x32_bf16 v[80:83], v[112:115], v[144:147], v[80:83]
s_waitcnt lgkmcnt(3)
buffer_load_dwordx4 v7, s[4:7], s56 offen offset:3072 lds
v_mfma_f32_16x16x32_bf16 v[156:159], v[84:87], v[172:175], v[156:159]
ds_read_b64_tr_b16 v[100:101], v14 offset:8192
s_add_u32 m0, s59, 32768
v_mfma_f32_16x16x32_bf16 v[20:23], v[84:87], v[116:119], v[20:23]
ds_read_b64_tr_b16 v[102:103], v14 offset:12288
s_add_u32 s56, s56, 128
v_mfma_f32_16x16x32_bf16 v[36:39], v[84:87], v[120:123], v[36:39]
ds_read_b128 v[132:135], v13 offset:0
v_alignbit_b32 v170, v208, v207, 16
v_mfma_f32_16x16x32_bf16 v[52:55], v[84:87], v[124:127], v[52:55]
buffer_load_dwordx4 v8, s[28:31], s57 offen offset:0 lds
v_mfma_f32_16x16x32_bf16 v[68:71], v[84:87], v[128:131], v[68:71]
ds_read_b128 v[136:139], v13 offset:2048
v_alignbit_b32 v171, v209, v208, 16
v_mfma_f32_16x16x32_bf16 v[160:163], v[88:91], v[172:175], v[160:163]
ds_read_b128 v[140:143], v13 offset:4096
v_accvgpr_write_b32 a248, v205
v_mfma_f32_16x16x32_bf16 v[24:27], v[88:91], v[116:119], v[24:27]
ds_read_b128 v[144:147], v13 offset:6144
v_accvgpr_write_b32 a249, v206
v_mfma_f32_16x16x32_bf16 v[40:43], v[88:91], v[120:123], v[40:43]
buffer_load_dwordx4 v9, s[28:31], s57 offen offset:1024 lds
v_mfma_f32_16x16x32_bf16 v[56:59], v[88:91], v[124:127], v[56:59]
ds_read_b64_tr_b16 v[104:105], v15 offset:8192
v_accvgpr_write_b32 a250, v207
v_mfma_f32_16x16x32_bf16 v[72:75], v[88:91], v[128:131], v[72:75]
s_waitcnt lgkmcnt(3)
ds_read_b64_tr_b16 v[106:107], v15 offset:12288
v_accvgpr_write_b32 a251, v208
v_mfma_f32_16x16x32_bf16 v[28:31], v[92:95], v[116:119], v[28:31]
ds_read_b64_tr_b16 v[108:109], v16 offset:8192
v_alignbit_b32 v224, v205, v204, 16
v_mfma_f32_16x16x32_bf16 v[44:47], v[92:95], v[120:123], v[44:47]
buffer_load_dwordx4 v10, s[28:31], s57 offen offset:2048 lds
v_mfma_f32_16x16x32_bf16 v[60:63], v[92:95], v[124:127], v[60:63]
ds_read_b64_tr_b16 v[110:111], v16 offset:12288
v_alignbit_b32 v225, v206, v205, 16
v_mfma_f32_16x16x32_bf16 v[76:79], v[92:95], v[128:131], v[76:79]
ds_read_b64_tr_b16 v[112:113], v17 offset:8192
v_alignbit_b32 v226, v207, v206, 16
v_mfma_f32_16x16x32_bf16 v[32:35], v[96:99], v[116:119], v[32:35]
ds_read_b64_tr_b16 v[114:115], v17 offset:12288
v_alignbit_b32 v227, v208, v207, 16
v_mfma_f32_16x16x32_bf16 v[48:51], v[96:99], v[120:123], v[48:51]
buffer_load_dwordx4 v11, s[28:31], s57 offen offset:3072 lds
v_mfma_f32_16x16x32_bf16 v[64:67], v[96:99], v[124:127], v[64:67]
s_sub_u32 s57, s56, 1280
s_min_u32 s56, s56, s57
v_mfma_f32_16x16x32_bf16 v[80:83], v[96:99], v[128:131], v[80:83]
s_mul_i32 s57, s56, 1728
v_lshlrev_b32 v211, 16, v211
v_mfma_f32_16x16x32_bf16 v[156:159], v[100:103], v[172:175], v[156:159]
v_lshlrev_b32 v253, 16, v253
v_add_f32 v211, v211, v253
v_mfma_f32_16x16x32_bf16 v[20:23], v[100:103], v[132:135], v[20:23]
v_cvt_pk_bf16_f32 v211, v211, v211
v_mfma_f32_16x16x32_bf16 v[36:39], v[100:103], v[136:139], v[36:39]
s_waitcnt vmcnt(8) lgkmcnt(0)
s_barrier
s_lshl_b32 s61, s51, 7
s_add_u32 s61, s61, 5288960
s_load_dword s63, s[44:45], s61
s_lshl_b32 s25, s75, 2
s_add_u32 s25, s25, s50
s_lshl_b32 s25, s25, 7
s_add_u32 s25, s25, 5292288
s_load_dword s24, s[44:45], s25
ds_read_b64_tr_b16 v[84:85], v14 offset:16384
s_add_u32 m0, s58, 0
v_mfma_f32_16x16x32_bf16 v[52:55], v[100:103], v[140:143], v[52:55]
s_nop 0
ds_read_b64_tr_b16 v[86:87], v14 offset:20480
v_mfma_f32_16x16x32_bf16 v[68:71], v[100:103], v[144:147], v[68:71]
ds_read_b128 v[116:119], v12 offset:16384
v_mfma_f32_16x16x32_bf16 v[160:163], v[104:107], v[172:175], v[160:163]
buffer_load_dwordx4 v4, s[4:7], s56 offen offset:0 lds
v_mfma_f32_16x16x32_bf16 v[24:27], v[104:107], v[132:135], v[24:27]
ds_read_b128 v[120:123], v12 offset:18432
v_mfma_f32_16x16x32_bf16 v[40:43], v[104:107], v[136:139], v[40:43]
ds_read_b128 v[124:127], v12 offset:20480
v_mfma_f32_16x16x32_bf16 v[56:59], v[104:107], v[140:143], v[56:59]
ds_read_b128 v[128:131], v12 offset:22528
v_mfma_f32_16x16x32_bf16 v[72:75], v[104:107], v[144:147], v[72:75]
buffer_load_dwordx4 v5, s[4:7], s56 offen offset:1024 lds
v_mfma_f32_16x16x32_bf16 v[28:31], v[108:111], v[132:135], v[28:31]
ds_read_b64_tr_b16 v[88:89], v15 offset:16384
v_mfma_f32_16x16x32_bf16 v[44:47], v[108:111], v[136:139], v[44:47]
ds_read_b64_tr_b16 v[90:91], v15 offset:20480
v_mfma_f32_16x16x32_bf16 v[60:63], v[108:111], v[140:143], v[60:63]
ds_read_b64_tr_b16 v[92:93], v16 offset:16384
v_mfma_f32_16x16x32_bf16 v[76:79], v[108:111], v[144:147], v[76:79]
buffer_load_dwordx4 v6, s[4:7], s56 offen offset:2048 lds
v_mfma_f32_16x16x32_bf16 v[32:35], v[112:115], v[132:135], v[32:35]
ds_read_b64_tr_b16 v[94:95], v16 offset:20480
v_mfma_f32_16x16x32_bf16 v[48:51], v[112:115], v[136:139], v[48:51]
ds_read_b64_tr_b16 v[96:97], v17 offset:16384
v_mfma_f32_16x16x32_bf16 v[64:67], v[112:115], v[140:143], v[64:67]
ds_read_b64_tr_b16 v[98:99], v17 offset:20480
v_mfma_f32_16x16x32_bf16 v[80:83], v[112:115], v[144:147], v[80:83]
s_waitcnt lgkmcnt(3)
buffer_load_dwordx4 v7, s[4:7], s56 offen offset:3072 lds
v_mfma_f32_16x16x32_bf16 v[156:159], v[84:87], v[172:175], v[156:159]
ds_read_b64_tr_b16 v[100:101], v14 offset:24576
s_add_u32 m0, s59, 0
v_mfma_f32_16x16x32_bf16 v[20:23], v[84:87], v[116:119], v[20:23]
ds_read_b64_tr_b16 v[102:103], v14 offset:28672
s_add_u32 s56, s56, 128
v_mfma_f32_16x16x32_bf16 v[36:39], v[84:87], v[120:123], v[36:39]
ds_read_b128 v[132:135], v13 offset:16384
v_mfma_f32_16x16x32_bf16 v[52:55], v[84:87], v[124:127], v[52:55]
buffer_load_dwordx4 v8, s[28:31], s57 offen offset:0 lds
v_mfma_f32_16x16x32_bf16 v[68:71], v[84:87], v[128:131], v[68:71]
ds_read_b128 v[136:139], v13 offset:18432
v_mfma_f32_16x16x32_bf16 v[160:163], v[88:91], v[172:175], v[160:163]
ds_read_b128 v[140:143], v13 offset:20480
v_mfma_f32_16x16x32_bf16 v[24:27], v[88:91], v[116:119], v[24:27]
ds_read_b128 v[144:147], v13 offset:22528
v_mfma_f32_16x16x32_bf16 v[40:43], v[88:91], v[120:123], v[40:43]
buffer_load_dwordx4 v9, s[28:31], s57 offen offset:1024 lds
v_mfma_f32_16x16x32_bf16 v[56:59], v[88:91], v[124:127], v[56:59]
ds_read_b64_tr_b16 v[104:105], v15 offset:24576
v_mfma_f32_16x16x32_bf16 v[72:75], v[88:91], v[128:131], v[72:75]
s_waitcnt lgkmcnt(3)
ds_read_b64_tr_b16 v[106:107], v15 offset:28672
v_mfma_f32_16x16x32_bf16 v[28:31], v[92:95], v[116:119], v[28:31]
ds_read_b64_tr_b16 v[108:109], v16 offset:24576
v_mfma_f32_16x16x32_bf16 v[44:47], v[92:95], v[120:123], v[44:47]
buffer_load_dwordx4 v10, s[28:31], s57 offen offset:2048 lds
v_mfma_f32_16x16x32_bf16 v[60:63], v[92:95], v[124:127], v[60:63]
ds_read_b64_tr_b16 v[110:111], v16 offset:28672
v_mfma_f32_16x16x32_bf16 v[76:79], v[92:95], v[128:131], v[76:79]
ds_read_b64_tr_b16 v[112:113], v17 offset:24576
v_mfma_f32_16x16x32_bf16 v[32:35], v[96:99], v[116:119], v[32:35]
ds_read_b64_tr_b16 v[114:115], v17 offset:28672
v_mfma_f32_16x16x32_bf16 v[48:51], v[96:99], v[120:123], v[48:51]
buffer_load_dwordx4 v11, s[28:31], s57 offen offset:3072 lds
v_mfma_f32_16x16x32_bf16 v[64:67], v[96:99], v[124:127], v[64:67]
s_sub_u32 s57, s56, 1280
s_min_u32 s56, s56, s57
v_mfma_f32_16x16x32_bf16 v[80:83], v[96:99], v[128:131], v[80:83]
s_mul_i32 s57, s56, 1728
v_mfma_f32_16x16x32_bf16 v[156:159], v[100:103], v[172:175], v[156:159]
v_mfma_f32_16x16x32_bf16 v[20:23], v[100:103], v[132:135], v[20:23]
v_mfma_f32_16x16x32_bf16 v[36:39], v[100:103], v[136:139], v[36:39]
s_waitcnt vmcnt(8) lgkmcnt(0)
s_barrier
s_cmp_eq_u32 s63, 6
s_cbranch_scc0 LS_fs
LR_fs:
s_cmp_eq_u32 s24, 14
s_cbranch_scc0 LS_fa
LR_fa:
ds_read_b64_tr_b16 v[84:85], v14 offset:32768
v_lshl_add_u32 v4, s60, 10, v18
v_mfma_f32_16x16x32_bf16 v[52:55], v[100:103], v[140:143], v[52:55]
ds_read_b64_tr_b16 v[86:87], v14 offset:36864
v_add_u32 v5, 1024, v4
v_mfma_f32_16x16x32_bf16 v[68:71], v[100:103], v[144:147], v[68:71]
ds_read_b128 v[116:119], v12 offset:32768
v_subrev_u32 v11, 7168, v5
v_mfma_f32_16x16x32_bf16 v[160:163], v[104:107], v[172:175], v[160:163]
buffer_load_dwordx2 v[148:149], v176, s[44:47], 0 offen offset:0 sc1
v_mfma_f32_16x16x32_bf16 v[24:27], v[104:107], v[132:135], v[24:27]
ds_read_b128 v[120:123], v12 offset:34816
v_min_u32 v5, v5, v11
v_mfma_f32_16x16x32_bf16 v[40:43], v[104:107], v[136:139], v[40:43]
buffer_load_dwordx2 v[150:151], v176, s[44:47], 0 offen offset:128 sc1
v_mfma_f32_16x16x32_bf16 v[56:59], v[104:107], v[140:143], v[56:59]
ds_read_b128 v[124:127], v12 offset:36864
v_add_u32 v6, 1024, v5
v_mfma_f32_16x16x32_bf16 v[72:75], v[104:107], v[144:147], v[72:75]
ds_read_b128 v[128:131], v12 offset:38912
v_subrev_u32 v11, 7168, v6
v_mfma_f32_16x16x32_bf16 v[28:31], v[108:111], v[132:135], v[28:31]
buffer_load_dwordx2 v[152:153], v176, s[44:47], 0 offen offset:256 sc1
v_mfma_f32_16x16x32_bf16 v[44:47], v[108:111], v[136:139], v[44:47]
ds_read_b64_tr_b16 v[88:89], v15 offset:32768
v_min_u32 v6, v6, v11
v_mfma_f32_16x16x32_bf16 v[60:63], v[108:111], v[140:143], v[60:63]
buffer_load_dwordx2 v[154:155], v176, s[44:47], 0 offen offset:384 sc1
v_mfma_f32_16x16x32_bf16 v[76:79], v[108:111], v[144:147], v[76:79]
ds_read_b64_tr_b16 v[90:91], v15 offset:36864
s_add_u32 m0, s70, 16384
v_mfma_f32_16x16x32_bf16 v[32:35], v[112:115], v[132:135], v[32:35]
s_nop 0
ds_read_b64_tr_b16 v[92:93], v16 offset:32768
v_add_u32 v7, 1024, v6
v_mfma_f32_16x16x32_bf16 v[48:51], v[112:115], v[136:139], v[48:51]
buffer_load_dwordx4 v244, s[32:35], s71 offen offset:0 lds
v_mfma_f32_16x16x32_bf16 v[64:67], v[112:115], v[140:143], v[64:67]
ds_read_b64_tr_b16 v[94:95], v16 offset:36864
v_subrev_u32 v11, 7168, v7
v_mfma_f32_16x16x32_bf16 v[80:83], v[112:115], v[144:147], v[80:83]
s_waitcnt lgkmcnt(3)
ds_read_b64_tr_b16 v[96:97], v17 offset:32768
v_min_u32 v7, v7, v11
v_mfma_f32_16x16x32_bf16 v[156:159], v[84:87], v[172:175], v[156:159]
buffer_load_dwordx4 v245, s[32:35], s71 offen offset:1024 lds
ds_read_b64_tr_b16 v[98:99], v17 offset:36864
v_mfma_f32_16x16x32_bf16 v[20:23], v[84:87], v[116:119], v[20:23]
ds_read_b64_tr_b16 v[100:101], v14 offset:40960
ds_read_b64_tr_b16 v[102:103], v14 offset:45056
v_mfma_f32_16x16x32_bf16 v[36:39], v[84:87], v[120:123], v[36:39]
buffer_load_dwordx4 v246, s[32:35], s71 offen offset:2048 lds
v_mfma_f32_16x16x32_bf16 v[52:55], v[84:87], v[124:127], v[52:55]
ds_read_b128 v[132:135], v13 offset:32768
v_add_u32 v8, 1024, v7
v_mfma_f32_16x16x32_bf16 v[68:71], v[84:87], v[128:131], v[68:71]
s_waitcnt lgkmcnt(4)
ds_read_b128 v[136:139], v13 offset:34816
v_subrev_u32 v11, 7168, v8
v_mfma_f32_16x16x32_bf16 v[160:163], v[88:91], v[172:175], v[160:163]
buffer_load_dwordx4 v247, s[32:35], s71 offen offset:3072 lds
v_mfma_f32_16x16x32_bf16 v[24:27], v[88:91], v[116:119], v[24:27]
ds_read_b128 v[140:143], v13 offset:36864
s_add_u32 s71, s71, 40960
s_sub_u32 s63, s71, 286720
s_min_u32 s71, s71, s63
v_mfma_f32_16x16x32_bf16 v[40:43], v[88:91], v[120:123], v[40:43]
ds_read_b128 v[144:147], v13 offset:38912
s_add_u32 m0, s70, 65536
v_mfma_f32_16x16x32_bf16 v[56:59], v[88:91], v[124:127], v[56:59]
s_nop 0
buffer_load_dwordx4 v244, s[32:35], s71 offen offset:0 lds
v_mfma_f32_16x16x32_bf16 v[72:75], v[88:91], v[128:131], v[72:75]
ds_read_b64_tr_b16 v[104:105], v15 offset:40960
v_min_u32 v8, v8, v11
v_mfma_f32_16x16x32_bf16 v[28:31], v[92:95], v[116:119], v[28:31]
buffer_load_dwordx4 v245, s[32:35], s71 offen offset:1024 lds
v_mfma_f32_16x16x32_bf16 v[44:47], v[92:95], v[120:123], v[44:47]
ds_read_b64_tr_b16 v[106:107], v15 offset:45056
v_add_u32 v9, 1024, v8
v_mfma_f32_16x16x32_bf16 v[60:63], v[92:95], v[124:127], v[60:63]
ds_read_b64_tr_b16 v[108:109], v16 offset:40960
v_subrev_u32 v11, 7168, v9
v_mfma_f32_16x16x32_bf16 v[76:79], v[92:95], v[128:131], v[76:79]
s_waitcnt lgkmcnt(3)
ds_read_b64_tr_b16 v[110:111], v16 offset:45056
v_min_u32 v9, v9, v11
v_mfma_f32_16x16x32_bf16 v[32:35], v[96:99], v[116:119], v[32:35]
buffer_load_dwordx4 v246, s[32:35], s71 offen offset:2048 lds
v_mfma_f32_16x16x32_bf16 v[48:51], v[96:99], v[120:123], v[48:51]
ds_read_b64_tr_b16 v[112:113], v17 offset:40960
v_add_u32 v10, 1024, v9
v_mfma_f32_16x16x32_bf16 v[64:67], v[96:99], v[124:127], v[64:67]
ds_read_b64_tr_b16 v[114:115], v17 offset:45056
v_subrev_u32 v11, 7168, v10
v_mfma_f32_16x16x32_bf16 v[80:83], v[96:99], v[128:131], v[80:83]
buffer_load_dwordx4 v247, s[32:35], s71 offen offset:3072 lds
v_mfma_f32_16x16x32_bf16 v[156:159], v[100:103], v[172:175], v[156:159]
s_add_u32 s71, s71, 40960
s_sub_u32 s63, s71, 286720
v_mfma_f32_16x16x32_bf16 v[20:23], v[100:103], v[132:135], v[20:23]
s_min_u32 s71, s71, s63
v_min_u32 v10, v10, v11
v_mfma_f32_16x16x32_bf16 v[36:39], v[100:103], v[136:139], v[36:39]
s_waitcnt vmcnt(12) lgkmcnt(0)
s_barrier
ds_read_b64_tr_b16 v[84:85], v14 offset:0
v_mfma_f32_16x16x32_bf16 v[52:55], v[100:103], v[140:143], v[52:55]
ds_read_b64_tr_b16 v[86:87], v14 offset:4096
v_mfma_f32_16x16x32_bf16 v[68:71], v[100:103], v[144:147], v[68:71]
ds_write_b128 v232, v[228:231]
v_mfma_f32_16x16x32_bf16 v[160:163], v[104:107], v[172:175], v[160:163]
buffer_load_dwordx4 a[16:19], v4, s[44:47], s17 offen sc1
v_mfma_f32_16x16x32_bf16 v[24:27], v[104:107], v[132:135], v[24:27]
ds_read_b128 v[116:119], v12 offset:0
v_mfma_f32_16x16x32_bf16 v[40:43], v[104:107], v[136:139], v[40:43]
buffer_load_dwordx4 a[36:39], v5, s[44:47], s17 offen sc1
v_mfma_f32_16x16x32_bf16 v[56:59], v[104:107], v[140:143], v[56:59]
ds_write_b128 v219, v[194:197] offset:32
v_mfma_f32_16x16x32_bf16 v[72:75], v[104:107], v[144:147], v[72:75]
ds_read_b128 v[120:123], v12 offset:2048
v_mfma_f32_16x16x32_bf16 v[28:31], v[108:111], v[132:135], v[28:31]
ds_write_b128 v219, v[180:183] offset:4192
v_mfma_f32_16x16x32_bf16 v[44:47], v[108:111], v[136:139], v[44:47]
ds_read_b128 v[124:127], v12 offset:4096
v_mfma_f32_16x16x32_bf16 v[60:63], v[108:111], v[140:143], v[60:63]
ds_read_b128 v[128:131], v12 offset:6144
v_mfma_f32_16x16x32_bf16 v[76:79], v[108:111], v[144:147], v[76:79]
ds_read_b64_tr_b16 v[88:89], v15 offset:0
v_mfma_f32_16x16x32_bf16 v[32:35], v[112:115], v[132:135], v[32:35]
ds_write_b128 v219, a[240:243] offset:8352
v_mfma_f32_16x16x32_bf16 v[48:51], v[112:115], v[136:139], v[48:51]
ds_read_b64_tr_b16 v[90:91], v15 offset:4096
v_mfma_f32_16x16x32_bf16 v[64:67], v[112:115], v[140:143], v[64:67]
ds_read_b64_tr_b16 v[92:93], v16 offset:0
v_mfma_f32_16x16x32_bf16 v[80:83], v[112:115], v[144:147], v[80:83]
s_waitcnt lgkmcnt(4)
ds_write_b128 v219, v[184:187] offset:12512
v_mfma_f32_16x16x32_bf16 v[156:159], v[84:87], v[172:175], v[156:159]
ds_read_b64_tr_b16 v[94:95], v16 offset:4096
ds_read_b64_tr_b16 v[96:97], v17 offset:0
v_mfma_f32_16x16x32_bf16 v[20:23], v[84:87], v[116:119], v[20:23]
ds_read_b64_tr_b16 v[98:99], v17 offset:4096
ds_read_b64_tr_b16 v[100:101], v14 offset:8192
v_mfma_f32_16x16x32_bf16 v[36:39], v[84:87], v[120:123], v[36:39]
ds_write_b128 v219, v[200:203] offset:21280
v_mfma_f32_16x16x32_bf16 v[52:55], v[84:87], v[124:127], v[52:55]
ds_read_b64_tr_b16 v[102:103], v14 offset:12288
v_mfma_f32_16x16x32_bf16 v[68:71], v[84:87], v[128:131], v[68:71]
s_waitcnt lgkmcnt(6)
ds_read_b128 v[132:135], v13 offset:0
v_mfma_f32_16x16x32_bf16 v[160:163], v[88:91], v[172:175], v[160:163]
ds_write_b128 v219, v[188:191] offset:25440
v_mfma_f32_16x16x32_bf16 v[24:27], v[88:91], v[116:119], v[24:27]
ds_read_b128 v[136:139], v13 offset:2048
v_mfma_f32_16x16x32_bf16 v[40:43], v[88:91], v[120:123], v[40:43]
ds_read_b128 v[140:143], v13 offset:4096
v_mfma_f32_16x16x32_bf16 v[56:59], v[88:91], v[124:127], v[56:59]
ds_read_b128 v[144:147], v13 offset:6144
v_mfma_f32_16x16x32_bf16 v[72:75], v[88:91], v[128:131], v[72:75]
s_waitcnt lgkmcnt(4)
ds_write_b128 v219, a[244:247] offset:29600
v_mfma_f32_16x16x32_bf16 v[28:31], v[92:95], v[116:119], v[28:31]
ds_read_b64_tr_b16 v[104:105], v15 offset:8192
v_mfma_f32_16x16x32_bf16 v[44:47], v[92:95], v[120:123], v[44:47]
ds_read_b64_tr_b16 v[106:107], v15 offset:12288
v_mfma_f32_16x16x32_bf16 v[60:63], v[92:95], v[124:127], v[60:63]
ds_read_b64_tr_b16 v[108:109], v16 offset:8192
v_mfma_f32_16x16x32_bf16 v[76:79], v[92:95], v[128:131], v[76:79]
ds_read_b64_tr_b16 v[110:111], v16 offset:12288
v_mfma_f32_16x16x32_bf16 v[32:35], v[96:99], v[116:119], v[32:35]
ds_read_b64_tr_b16 v[112:113], v17 offset:8192
v_mfma_f32_16x16x32_bf16 v[48:51], v[96:99], v[120:123], v[48:51]
ds_write_b128 v219, v[164:167] offset:33760
v_mfma_f32_16x16x32_bf16 v[64:67], v[96:99], v[124:127], v[64:67]
ds_read_b64_tr_b16 v[114:115], v17 offset:12288
v_mfma_f32_16x16x32_bf16 v[80:83], v[96:99], v[128:131], v[80:83]
ds_write_b128 v219, v[206:209] offset:42528
v_mfma_f32_16x16x32_bf16 v[156:159], v[100:103], v[172:175], v[156:159]
v_mfma_f32_16x16x32_bf16 v[20:23], v[100:103], v[132:135], v[20:23]
s_waitcnt lgkmcnt(3)
ds_write_b128 v219, v[168:171] offset:46688
v_mfma_f32_16x16x32_bf16 v[36:39], v[100:103], v[136:139], v[36:39]
v_mfma_f32_16x16x32_bf16 v[52:55], v[100:103], v[140:143], v[52:55]
v_mfma_f32_16x16x32_bf16 v[68:71], v[100:103], v[144:147], v[68:71]
ds_write_b128 v219, a[248:251] offset:50848
v_mfma_f32_16x16x32_bf16 v[160:163], v[104:107], v[172:175], v[160:163]
v_mfma_f32_16x16x32_bf16 v[24:27], v[104:107], v[132:135], v[24:27]
v_mfma_f32_16x16x32_bf16 v[40:43], v[104:107], v[136:139], v[40:43]
ds_write_b128 v219, v[224:227] offset:55008
v_mfma_f32_16x16x32_bf16 v[56:59], v[104:107], v[140:143], v[56:59]
ds_write_b128 v177, v[156:159]
v_mfma_f32_16x16x32_bf16 v[72:75], v[104:107], v[144:147], v[72:75]
v_mfma_f32_16x16x32_bf16 v[28:31], v[108:111], v[132:135], v[28:31]
ds_write_b16 v240, v211
v_mfma_f32_16x16x32_bf16 v[44:47], v[108:111], v[136:139], v[44:47]
v_mfma_f32_16x16x32_bf16 v[60:63], v[108:111], v[140:143], v[60:63]
v_mfma_f32_16x16x32_bf16 v[76:79], v[108:111], v[144:147], v[76:79]
s_waitcnt lgkmcnt(1)
ds_write_b128 v177, v[160:163] offset:64
v_mfma_f32_16x16x32_bf16 v[32:35], v[112:115], v[132:135], v[32:35]
v_mfma_f32_16x16x32_bf16 v[48:51], v[112:115], v[136:139], v[48:51]
v_mfma_f32_16x16x32_bf16 v[64:67], v[112:115], v[140:143], v[64:67]
v_mfma_f32_16x16x32_bf16 v[80:83], v[112:115], v[144:147], v[80:83]
s_waitcnt lgkmcnt(0)
s_barrier
ds_read_b128 v[164:167], v178 offset:0
ds_read_b128 v[168:171], v178 offset:64
s_waitcnt vmcnt(10)
v_mul_f32 v84, 0xbfb8aa3b, v149
v_mul_f32 v86, 0xbfb8aa3b, v151
v_mul_f32 v88, 0xbfb8aa3b, v153
v_mul_f32 v90, 0xbfb8aa3b, v155
v_pk_fma_f32 v[20:21], v[156:157], v[148:149], v[20:21] op_sel_hi:[1,0,1] neg_lo:[0,1,0] neg_hi:[0,1,0]
v_pk_fma_f32 v[22:23], v[158:159], v[148:149], v[22:23] op_sel_hi:[1,0,1] neg_lo:[0,1,0] neg_hi:[0,1,0]
v_pk_mul_f32 v[20:21], v[20:21], v[84:85] op_sel_hi:[1,0]
v_pk_mul_f32 v[22:23], v[22:23], v[84:85] op_sel_hi:[1,0]
v_exp_f32 v92, v20
v_exp_f32 v93, v21
v_exp_f32 v94, v22
v_exp_f32 v95, v23
v_pk_add_f32 v[92:93], v[92:93], 1.0 op_sel_hi:[1,0]
v_pk_add_f32 v[94:95], v[94:95], 1.0 op_sel_hi:[1,0]
v_rcp_f32 v92, v92
v_rcp_f32 v93, v93
v_rcp_f32 v94, v94
v_rcp_f32 v95, v95
s_load_dword s20, s[44:45], s66
s_load_dword s21, s[44:45], s67
v_pk_mul_f32 v[20:21], v[20:21], v[92:93]
v_pk_mul_f32 v[22:23], v[22:23], v[94:95]
v_cvt_pk_bf16_f32 v100, v20, v21
v_cvt_pk_bf16_f32 v101, v22, v23
v_pk_fma_f32 v[24:25], v[160:161], v[148:149], v[24:25] op_sel_hi:[1,0,1] neg_lo:[0,1,0] neg_hi:[0,1,0]
v_pk_fma_f32 v[26:27], v[162:163], v[148:149], v[26:27] op_sel_hi:[1,0,1] neg_lo:[0,1,0] neg_hi:[0,1,0]
v_pk_mul_f32 v[24:25], v[24:25], v[84:85] op_sel_hi:[1,0]
v_pk_mul_f32 v[26:27], v[26:27], v[84:85] op_sel_hi:[1,0]
v_exp_f32 v96, v24
v_exp_f32 v97, v25
v_exp_f32 v98, v26
v_exp_f32 v99, v27
v_pk_add_f32 v[96:97], v[96:97], 1.0 op_sel_hi:[1,0]
v_pk_add_f32 v[98:99], v[98:99], 1.0 op_sel_hi:[1,0]
v_rcp_f32 v96, v96
v_rcp_f32 v97, v97
v_rcp_f32 v98, v98
v_rcp_f32 v99, v99
v_pk_mul_f32 v[24:25], v[24:25], v[96:97]
v_pk_mul_f32 v[26:27], v[26:27], v[98:99]
v_cvt_pk_bf16_f32 v102, v24, v25
v_cvt_pk_bf16_f32 v103, v26, v27
buffer_store_dwordx4 v[100:103], v18, s[44:47], s64 offen sc1
s_add_u32 s64, s64, 57344
v_pk_fma_f32 v[36:37], v[156:157], v[150:151], v[36:37] op_sel_hi:[1,0,1] neg_lo:[0,1,0] neg_hi:[0,1,0]
v_pk_fma_f32 v[38:39], v[158:159], v[150:151], v[38:39] op_sel_hi:[1,0,1] neg_lo:[0,1,0] neg_hi:[0,1,0]
v_pk_mul_f32 v[36:37], v[36:37], v[86:87] op_sel_hi:[1,0]
v_pk_mul_f32 v[38:39], v[38:39], v[86:87] op_sel_hi:[1,0]
v_exp_f32 v92, v36
v_exp_f32 v93, v37
v_exp_f32 v94, v38
v_exp_f32 v95, v39
v_pk_add_f32 v[92:93], v[92:93], 1.0 op_sel_hi:[1,0]
v_pk_add_f32 v[94:95], v[94:95], 1.0 op_sel_hi:[1,0]
v_rcp_f32 v92, v92
v_rcp_f32 v93, v93
v_rcp_f32 v94, v94
v_rcp_f32 v95, v95
v_pk_mul_f32 v[36:37], v[36:37], v[92:93]
v_pk_mul_f32 v[38:39], v[38:39], v[94:95]
v_cvt_pk_bf16_f32 v104, v36, v37
v_cvt_pk_bf16_f32 v105, v38, v39
v_pk_fma_f32 v[40:41], v[160:161], v[150:151], v[40:41] op_sel_hi:[1,0,1] neg_lo:[0,1,0] neg_hi:[0,1,0]
v_pk_fma_f32 v[42:43], v[162:163], v[150:151], v[42:43] op_sel_hi:[1,0,1] neg_lo:[0,1,0] neg_hi:[0,1,0]
v_pk_mul_f32 v[40:41], v[40:41], v[86:87] op_sel_hi:[1,0]
v_pk_mul_f32 v[42:43], v[42:43], v[86:87] op_sel_hi:[1,0]
v_exp_f32 v96, v40
v_exp_f32 v97, v41
v_exp_f32 v98, v42
v_exp_f32 v99, v43
v_pk_add_f32 v[96:97], v[96:97], 1.0 op_sel_hi:[1,0]
v_pk_add_f32 v[98:99], v[98:99], 1.0 op_sel_hi:[1,0]
v_rcp_f32 v96, v96
v_rcp_f32 v97, v97
v_rcp_f32 v98, v98
v_rcp_f32 v99, v99
v_pk_mul_f32 v[40:41], v[40:41], v[96:97]
v_pk_mul_f32 v[42:43], v[42:43], v[98:99]
v_cvt_pk_bf16_f32 v106, v40, v41
v_cvt_pk_bf16_f32 v107, v42, v43
buffer_store_dwordx4 v[104:107], v18, s[44:47], s64 offen sc1
s_add_u32 s64, s64, 57344
v_pk_fma_f32 v[52:53], v[156:157], v[152:153], v[52:53] op_sel_hi:[1,0,1] neg_lo:[0,1,0] neg_hi:[0,1,0]
v_pk_fma_f32 v[54:55], v[158:159], v[152:153], v[54:55] op_sel_hi:[1,0,1] neg_lo:[0,1,0] neg_hi:[0,1,0]
v_pk_mul_f32 v[52:53], v[52:53], v[88:89] op_sel_hi:[1,0]
v_pk_mul_f32 v[54:55], v[54:55], v[88:89] op_sel_hi:[1,0]
v_exp_f32 v92, v52
v_exp_f32 v93, v53
v_exp_f32 v94, v54
v_exp_f32 v95, v55
v_pk_add_f32 v[92:93], v[92:93], 1.0 op_sel_hi:[1,0]
v_pk_add_f32 v[94:95], v[94:95], 1.0 op_sel_hi:[1,0]
v_rcp_f32 v92, v92
v_rcp_f32 v93, v93
v_rcp_f32 v94, v94
v_rcp_f32 v95, v95
v_pk_mul_f32 v[52:53], v[52:53], v[92:93]
v_pk_mul_f32 v[54:55], v[54:55], v[94:95]
v_cvt_pk_bf16_f32 v100, v52, v53
v_cvt_pk_bf16_f32 v101, v54, v55
v_pk_fma_f32 v[56:57], v[160:161], v[152:153], v[56:57] op_sel_hi:[1,0,1] neg_lo:[0,1,0] neg_hi:[0,1,0]
v_pk_fma_f32 v[58:59], v[162:163], v[152:153], v[58:59] op_sel_hi:[1,0,1] neg_lo:[0,1,0] neg_hi:[0,1,0]
v_pk_mul_f32 v[56:57], v[56:57], v[88:89] op_sel_hi:[1,0]
v_pk_mul_f32 v[58:59], v[58:59], v[88:89] op_sel_hi:[1,0]
v_exp_f32 v96, v56
v_exp_f32 v97, v57
v_exp_f32 v98, v58
v_exp_f32 v99, v59
v_pk_add_f32 v[96:97], v[96:97], 1.0 op_sel_hi:[1,0]
v_pk_add_f32 v[98:99], v[98:99], 1.0 op_sel_hi:[1,0]
v_rcp_f32 v96, v96
v_rcp_f32 v97, v97
v_rcp_f32 v98, v98
v_rcp_f32 v99, v99
v_pk_mul_f32 v[56:57], v[56:57], v[96:97]
v_pk_mul_f32 v[58:59], v[58:59], v[98:99]
v_cvt_pk_bf16_f32 v102, v56, v57
v_cvt_pk_bf16_f32 v103, v58, v59
buffer_store_dwordx4 v[100:103], v18, s[44:47], s64 offen sc1
s_add_u32 s64, s64, 57344
v_pk_fma_f32 v[68:69], v[156:157], v[154:155], v[68:69] op_sel_hi:[1,0,1] neg_lo:[0,1,0] neg_hi:[0,1,0]
v_pk_fma_f32 v[70:71], v[158:159], v[154:155], v[70:71] op_sel_hi:[1,0,1] neg_lo:[0,1,0] neg_hi:[0,1,0]
v_pk_mul_f32 v[68:69], v[68:69], v[90:91] op_sel_hi:[1,0]
v_pk_mul_f32 v[70:71], v[70:71], v[90:91] op_sel_hi:[1,0]
v_exp_f32 v92, v68
v_exp_f32 v93, v69
v_exp_f32 v94, v70
v_exp_f32 v95, v71
v_pk_add_f32 v[92:93], v[92:93], 1.0 op_sel_hi:[1,0]
v_pk_add_f32 v[94:95], v[94:95], 1.0 op_sel_hi:[1,0]
v_rcp_f32 v92, v92
v_rcp_f32 v93, v93
v_rcp_f32 v94, v94
v_rcp_f32 v95, v95
s_waitcnt lgkmcnt(0)
s_min_u32 s20, s20, s21
s_cmp_eq_u32 s20, 32
s_cbranch_scc0 L_uskip
s_lshl_b32 s62, s50, 10
s_add_u32 m0, s62, 114944
s_nop 0
buffer_load_dwordx4 v19, s[44:47], s72 offen sc1 lds
s_add_u32 m0, s62, 136192
s_nop 0
buffer_load_dwordx4 v19, s[44:47], s73 offen sc1 lds
s_add_u32 m0, s62, 157440
s_nop 0
buffer_load_dwordx4 v19, s[44:47], s74 offen sc1 lds
s_mov_b32 s68, 1
L_uskip:
v_pk_mul_f32 v[68:69], v[68:69], v[92:93]
v_pk_mul_f32 v[70:71], v[70:71], v[94:95]
v_cvt_pk_bf16_f32 v104, v68, v69
v_cvt_pk_bf16_f32 v105, v70, v71
v_pk_fma_f32 v[72:73], v[160:161], v[154:155], v[72:73] op_sel_hi:[1,0,1] neg_lo:[0,1,0] neg_hi:[0,1,0]
v_pk_fma_f32 v[74:75], v[162:163], v[154:155], v[74:75] op_sel_hi:[1,0,1] neg_lo:[0,1,0] neg_hi:[0,1,0]
v_pk_mul_f32 v[72:73], v[72:73], v[90:91] op_sel_hi:[1,0]
v_pk_mul_f32 v[74:75], v[74:75], v[90:91] op_sel_hi:[1,0]
v_exp_f32 v96, v72
v_exp_f32 v97, v73
v_exp_f32 v98, v74
v_exp_f32 v99, v75
v_pk_add_f32 v[96:97], v[96:97], 1.0 op_sel_hi:[1,0]
v_pk_add_f32 v[98:99], v[98:99], 1.0 op_sel_hi:[1,0]
v_rcp_f32 v96, v96
v_rcp_f32 v97, v97
v_rcp_f32 v98, v98
v_rcp_f32 v99, v99
v_pk_mul_f32 v[72:73], v[72:73], v[96:97]
v_pk_mul_f32 v[74:75], v[74:75], v[98:99]
v_cvt_pk_bf16_f32 v106, v72, v73
v_cvt_pk_bf16_f32 v107, v74, v75
buffer_store_dwordx4 v[104:107], v18, s[44:47], s64 offen sc1
v_pk_fma_f32 v[28:29], v[164:165], v[148:149], v[28:29] op_sel_hi:[1,0,1] neg_lo:[0,1,0] neg_hi:[0,1,0]
v_pk_fma_f32 v[30:31], v[166:167], v[148:149], v[30:31] op_sel_hi:[1,0,1] neg_lo:[0,1,0] neg_hi:[0,1,0]
v_pk_mul_f32 v[28:29], v[28:29], v[84:85] op_sel_hi:[1,0]
v_pk_mul_f32 v[30:31], v[30:31], v[84:85] op_sel_hi:[1,0]
v_exp_f32 v92, v28
v_exp_f32 v93, v29
v_exp_f32 v94, v30
v_exp_f32 v95, v31
v_pk_add_f32 v[92:93], v[92:93], 1.0 op_sel_hi:[1,0]
v_pk_add_f32 v[94:95], v[94:95], 1.0 op_sel_hi:[1,0]
v_rcp_f32 v92, v92
v_rcp_f32 v93, v93
v_rcp_f32 v94, v94
v_rcp_f32 v95, v95
v_pk_mul_f32 v[28:29], v[28:29], v[92:93]
v_pk_mul_f32 v[30:31], v[30:31], v[94:95]
v_cvt_pk_bf16_f32 v100, v28, v29
v_cvt_pk_bf16_f32 v101, v30, v31
v_pk_fma_f32 v[32:33], v[168:169], v[148:149], v[32:33] op_sel_hi:[1,0,1] neg_lo:[0,1,0] neg_hi:[0,1,0]
v_pk_fma_f32 v[34:35], v[170:171], v[148:149], v[34:35] op_sel_hi:[1,0,1] neg_lo:[0,1,0] neg_hi:[0,1,0]
v_pk_mul_f32 v[32:33], v[32:33], v[84:85] op_sel_hi:[1,0]
v_pk_mul_f32 v[34:35], v[34:35], v[84:85] op_sel_hi:[1,0]
v_exp_f32 v96, v32
v_exp_f32 v97, v33
v_exp_f32 v98, v34
v_exp_f32 v99, v35
v_pk_add_f32 v[96:97], v[96:97], 1.0 op_sel_hi:[1,0]
v_pk_add_f32 v[98:99], v[98:99], 1.0 op_sel_hi:[1,0]
v_rcp_f32 v96, v96
v_rcp_f32 v97, v97
v_rcp_f32 v98, v98
v_rcp_f32 v99, v99
v_pk_mul_f32 v[32:33], v[32:33], v[96:97]
v_pk_mul_f32 v[34:35], v[34:35], v[98:99]
v_cvt_pk_bf16_f32 v102, v32, v33
v_cvt_pk_bf16_f32 v103, v34, v35
buffer_store_dwordx4 v[100:103], v18, s[44:47], s65 offen sc1
s_add_u32 s65, s65, 57344
v_pk_fma_f32 v[44:45], v[164:165], v[150:151], v[44:45] op_sel_hi:[1,0,1] neg_lo:[0,1,0] neg_hi:[0,1,0]
v_pk_fma_f32 v[46:47], v[166:167], v[150:151], v[46:47] op_sel_hi:[1,0,1] neg_lo:[0,1,0] neg_hi:[0,1,0]
v_pk_mul_f32 v[44:45], v[44:45], v[86:87] op_sel_hi:[1,0]
v_pk_mul_f32 v[46:47], v[46:47], v[86:87] op_sel_hi:[1,0]
v_exp_f32 v92, v44
v_exp_f32 v93, v45
v_exp_f32 v94, v46
v_exp_f32 v95, v47
v_pk_add_f32 v[92:93], v[92:93], 1.0 op_sel_hi:[1,0]
v_pk_add_f32 v[94:95], v[94:95], 1.0 op_sel_hi:[1,0]
v_rcp_f32 v92, v92
v_rcp_f32 v93, v93
v_rcp_f32 v94, v94
v_rcp_f32 v95, v95
v_pk_mul_f32 v[44:45], v[44:45], v[92:93]
v_pk_mul_f32 v[46:47], v[46:47], v[94:95]
v_cvt_pk_bf16_f32 v104, v44, v45
v_cvt_pk_bf16_f32 v105, v46, v47
v_pk_fma_f32 v[48:49], v[168:169], v[150:151], v[48:49] op_sel_hi:[1,0,1] neg_lo:[0,1,0] neg_hi:[0,1,0]
v_pk_fma_f32 v[50:51], v[170:171], v[150:151], v[50:51] op_sel_hi:[1,0,1] neg_lo:[0,1,0] neg_hi:[0,1,0]
v_pk_mul_f32 v[48:49], v[48:49], v[86:87] op_sel_hi:[1,0]
v_pk_mul_f32 v[50:51], v[50:51], v[86:87] op_sel_hi:[1,0]
v_exp_f32 v96, v48
v_exp_f32 v97, v49
v_exp_f32 v98, v50
v_exp_f32 v99, v51
v_pk_add_f32 v[96:97], v[96:97], 1.0 op_sel_hi:[1,0]
v_pk_add_f32 v[98:99], v[98:99], 1.0 op_sel_hi:[1,0]
v_rcp_f32 v96, v96
v_rcp_f32 v97, v97
v_rcp_f32 v98, v98
v_rcp_f32 v99, v99
v_pk_mul_f32 v[48:49], v[48:49], v[96:97]
v_pk_mul_f32 v[50:51], v[50:51], v[98:99]
v_cvt_pk_bf16_f32 v106, v48, v49
v_cvt_pk_bf16_f32 v107, v50, v51
buffer_store_dwordx4 v[104:107], v18, s[44:47], s65 offen sc1
s_add_u32 s65, s65, 57344
v_pk_fma_f32 v[60:61], v[164:165], v[152:153], v[60:61] op_sel_hi:[1,0,1] neg_lo:[0,1,0] neg_hi:[0,1,0]
v_pk_fma_f32 v[62:63], v[166:167], v[152:153], v[62:63] op_sel_hi:[1,0,1] neg_lo:[0,1,0] neg_hi:[0,1,0]
v_pk_mul_f32 v[60:61], v[60:61], v[88:89] op_sel_hi:[1,0]
v_pk_mul_f32 v[62:63], v[62:63], v[88:89] op_sel_hi:[1,0]
v_exp_f32 v92, v60
v_exp_f32 v93, v61
v_exp_f32 v94, v62
v_exp_f32 v95, v63
v_pk_add_f32 v[92:93], v[92:93], 1.0 op_sel_hi:[1,0]
v_pk_add_f32 v[94:95], v[94:95], 1.0 op_sel_hi:[1,0]
v_rcp_f32 v92, v92
v_rcp_f32 v93, v93
v_rcp_f32 v94, v94
v_rcp_f32 v95, v95
v_pk_mul_f32 v[60:61], v[60:61], v[92:93]
v_pk_mul_f32 v[62:63], v[62:63], v[94:95]
v_cvt_pk_bf16_f32 v100, v60, v61
v_cvt_pk_bf16_f32 v101, v62, v63
v_pk_fma_f32 v[64:65], v[168:169], v[152:153], v[64:65] op_sel_hi:[1,0,1] neg_lo:[0,1,0] neg_hi:[0,1,0]
v_pk_fma_f32 v[66:67], v[170:171], v[152:153], v[66:67] op_sel_hi:[1,0,1] neg_lo:[0,1,0] neg_hi:[0,1,0]
v_pk_mul_f32 v[64:65], v[64:65], v[88:89] op_sel_hi:[1,0]
v_pk_mul_f32 v[66:67], v[66:67], v[88:89] op_sel_hi:[1,0]
v_exp_f32 v96, v64
v_exp_f32 v97, v65
v_exp_f32 v98, v66
v_exp_f32 v99, v67
v_pk_add_f32 v[96:97], v[96:97], 1.0 op_sel_hi:[1,0]
v_pk_add_f32 v[98:99], v[98:99], 1.0 op_sel_hi:[1,0]
v_rcp_f32 v96, v96
v_rcp_f32 v97, v97
v_rcp_f32 v98, v98
v_rcp_f32 v99, v99
v_pk_mul_f32 v[64:65], v[64:65], v[96:97]
v_pk_mul_f32 v[66:67], v[66:67], v[98:99]
v_cvt_pk_bf16_f32 v102, v64, v65
v_cvt_pk_bf16_f32 v103, v66, v67
buffer_store_dwordx4 v[100:103], v18, s[44:47], s65 offen sc1
s_add_u32 s65, s65, 57344
v_pk_fma_f32 v[76:77], v[164:165], v[154:155], v[76:77] op_sel_hi:[1,0,1] neg_lo:[0,1,0] neg_hi:[0,1,0]
v_pk_fma_f32 v[78:79], v[166:167], v[154:155], v[78:79] op_sel_hi:[1,0,1] neg_lo:[0,1,0] neg_hi:[0,1,0]
v_pk_mul_f32 v[76:77], v[76:77], v[90:91] op_sel_hi:[1,0]
v_pk_mul_f32 v[78:79], v[78:79], v[90:91] op_sel_hi:[1,0]
v_exp_f32 v92, v76
v_exp_f32 v93, v77
v_exp_f32 v94, v78
v_exp_f32 v95, v79
v_pk_add_f32 v[92:93], v[92:93], 1.0 op_sel_hi:[1,0]
v_pk_add_f32 v[94:95], v[94:95], 1.0 op_sel_hi:[1,0]
v_rcp_f32 v92, v92
v_rcp_f32 v93, v93
v_rcp_f32 v94, v94
v_rcp_f32 v95, v95
v_pk_mul_f32 v[76:77], v[76:77], v[92:93]
v_pk_mul_f32 v[78:79], v[78:79], v[94:95]
v_cvt_pk_bf16_f32 v104, v76, v77
v_cvt_pk_bf16_f32 v105, v78, v79
v_pk_fma_f32 v[80:81], v[168:169], v[154:155], v[80:81] op_sel_hi:[1,0,1] neg_lo:[0,1,0] neg_hi:[0,1,0]
v_pk_fma_f32 v[82:83], v[170:171], v[154:155], v[82:83] op_sel_hi:[1,0,1] neg_lo:[0,1,0] neg_hi:[0,1,0]
v_pk_mul_f32 v[80:81], v[80:81], v[90:91] op_sel_hi:[1,0]
v_pk_mul_f32 v[82:83], v[82:83], v[90:91] op_sel_hi:[1,0]
v_exp_f32 v96, v80
v_exp_f32 v97, v81
v_exp_f32 v98, v82
v_exp_f32 v99, v83
v_pk_add_f32 v[96:97], v[96:97], 1.0 op_sel_hi:[1,0]
v_pk_add_f32 v[98:99], v[98:99], 1.0 op_sel_hi:[1,0]
v_rcp_f32 v96, v96
v_rcp_f32 v97, v97
v_rcp_f32 v98, v98
v_rcp_f32 v99, v99
v_pk_mul_f32 v[80:81], v[80:81], v[96:97]
v_pk_mul_f32 v[82:83], v[82:83], v[98:99]
v_cvt_pk_bf16_f32 v106, v80, v81
v_cvt_pk_bf16_f32 v107, v82, v83
buffer_store_dwordx4 v[104:107], v18, s[44:47], s65 offen sc1
L_conv:
s_cmp_eq_u32 s68, 0
s_cbranch_scc1 LS_fk
s_waitcnt vmcnt(5)
LR_fk:
s_waitcnt lgkmcnt(0)
s_barrier
s_bitcmp1_b32 s49, 0
s_cbranch_scc1 LC_m1
LC_m0:
ds_read_b64 v[112:113], v214 offset:3584
ds_read_b64 v[114:115], v214 offset:3592
ds_read_b128 v[148:151], v215 offset:3584
ds_read_b64 v[108:109], v214 offset:3072
ds_read_b64 v[110:111], v214 offset:3080
ds_read_b128 v[152:155], v215 offset:3072
ds_read_b64 v[104:105], v214 offset:2560
ds_read_b64 v[106:107], v214 offset:2568
ds_read_b128 v[156:159], v215 offset:2560
s_waitcnt lgkmcnt(6)
v_mfma_f32_16x16x32_bf16 v[64:67], v[112:115], v[148:151], 0
s_waitcnt lgkmcnt(4)
ds_read_b64 v[100:101], v214 offset:2048
ds_read_b64 v[102:103], v214 offset:2056
v_mfma_f32_16x16x32_bf16 v[60:63], v[108:111], v[148:151], 0
s_waitcnt lgkmcnt(5)
ds_read_b128 v[160:163], v215 offset:2048
ds_read_b64 v[96:97], v214 offset:1536
v_mfma_f32_16x16x32_bf16 v[64:67], v[108:111], v[152:155], v[64:67]
s_waitcnt lgkmcnt(5)
ds_read_b64 v[98:99], v214 offset:1544
ds_read_b128 v[164:167], v215 offset:1536
v_mfma_f32_16x16x32_bf16 v[60:63], v[104:107], v[152:155], v[60:63]
s_waitcnt lgkmcnt(6)
ds_read_b64 v[92:93], v214 offset:1024
ds_read_b64 v[94:95], v214 offset:1032
s_add_u32 m0, s70, 32768
v_mfma_f32_16x16x32_bf16 v[64:67], v[104:107], v[156:159], v[64:67]
s_waitcnt lgkmcnt(6)
ds_read_b128 v[168:171], v215 offset:1024
ds_read_b64 v[88:89], v214 offset:512
s_nop 0
v_mfma_f32_16x16x32_bf16 v[60:63], v[100:103], v[156:159], v[60:63]
s_waitcnt lgkmcnt(7)
ds_read_b64 v[90:91], v214 offset:520
ds_read_b128 v[172:175], v215 offset:512
v_mfma_f32_16x16x32_bf16 v[64:67], v[100:103], v[160:163], v[64:67]
s_waitcnt lgkmcnt(7)
buffer_load_dwordx4 v244, s[32:35], s71 offen offset:0 lds
ds_read_b64 v[84:85], v214 offset:0
v_mfma_f32_16x16x32_bf16 v[60:63], v[96:99], v[160:163], v[60:63]
s_waitcnt lgkmcnt(7)
ds_read_b64 v[86:87], v214 offset:8
ds_read_b128 v[176:179], v215 offset:0
v_mfma_f32_16x16x32_bf16 v[64:67], v[96:99], v[164:167], v[64:67]
s_waitcnt lgkmcnt(7)
ds_read_b64 v[144:145], v214 offset:3648
ds_read_b64 v[146:147], v214 offset:3656
v_mfma_f32_16x16x32_bf16 v[60:63], v[92:95], v[164:167], v[60:63]
s_waitcnt lgkmcnt(7)
buffer_load_dwordx4 v245, s[32:35], s71 offen offset:1024 lds
ds_read_b128 v[180:183], v215 offset:3648
v_mfma_f32_16x16x32_bf16 v[64:67], v[92:95], v[168:171], v[64:67]
s_waitcnt lgkmcnt(6)
ds_read_b64 v[140:141], v214 offset:3136
ds_read_b64 v[142:143], v214 offset:3144
v_mfma_f32_16x16x32_bf16 v[56:59], v[88:91], v[148:151], 0
ds_read_b128 v[184:187], v215 offset:3136
ds_read_b64 v[136:137], v214 offset:2624
v_mfma_f32_16x16x32_bf16 v[60:63], v[88:91], v[168:171], v[60:63]
ds_read_b64 v[138:139], v214 offset:2632
ds_read_b128 v[188:191], v215 offset:2624
v_mfma_f32_16x16x32_bf16 v[64:67], v[88:91], v[172:175], v[64:67]
s_waitcnt lgkmcnt(7)
buffer_load_dwordx4 v246, s[32:35], s71 offen offset:2048 lds
ds_read_b64 v[132:133], v214 offset:2112
v_mfma_f32_16x16x32_bf16 v[52:55], v[84:87], v[148:151], 0
ds_read_b64 v[134:135], v214 offset:2120
ds_read_b128 v[192:195], v215 offset:2112
v_mfma_f32_16x16x32_bf16 v[56:59], v[84:87], v[152:155], v[56:59]
ds_read_b64 v[128:129], v214 offset:1600
ds_read_b64 v[130:131], v214 offset:1608
v_mfma_f32_16x16x32_bf16 v[60:63], v[84:87], v[172:175], v[60:63]
ds_read_b128 v[196:199], v215 offset:1600
buffer_load_dwordx4 v247, s[32:35], s71 offen offset:3072 lds
v_mfma_f32_16x16x32_bf16 v[64:67], v[84:87], v[176:179], v[64:67]
s_waitcnt lgkmcnt(6)
ds_read_b64 v[124:125], v214 offset:1088
ds_read_b64 v[126:127], v214 offset:1096
v_mfma_f32_16x16x32_bf16 v[64:67], v[144:147], v[180:183], v[64:67]
ds_read_b128 v[200:203], v215 offset:1088
ds_read_b64 v[120:121], v214 offset:576
v_mfma_f32_16x16x32_bf16 v[60:63], v[140:143], v[180:183], v[60:63]
ds_read_b64 v[122:123], v214 offset:584
s_add_u32 s71, s71, 40960
v_mfma_f32_16x16x32_bf16 v[64:67], v[140:143], v[184:187], v[64:67]
ds_read_b128 v[204:207], v215 offset:576
s_sub_u32 s63, s71, 286720
v_mfma_f32_16x16x32_bf16 v[60:63], v[136:139], v[184:187], v[60:63]
ds_read_b64 v[116:117], v214 offset:64
s_min_u32 s71, s71, s63
v_mfma_f32_16x16x32_bf16 v[64:67], v[136:139], v[188:191], v[64:67]
s_waitcnt lgkmcnt(5)
buffer_load_dwordx4 a[56:59], v6, s[44:47], s17 offen sc1
ds_read_b64 v[118:119], v214 offset:72
v_mfma_f32_16x16x32_bf16 v[60:63], v[132:135], v[188:191], v[60:63]
ds_read_b128 v[208:211], v215 offset:64
ds_read_b64 v[112:113], v212 offset:3584
v_mfma_f32_16x16x32_bf16 v[64:67], v[132:135], v[192:195], v[64:67]
ds_read_b64 v[114:115], v212 offset:3592
s_add_u32 m0, s70, 49152
v_mfma_f32_16x16x32_bf16 v[60:63], v[128:131], v[192:195], v[60:63]
s_nop 0
buffer_load_dwordx4 v244, s[32:35], s71 offen offset:0 lds
v_mfma_f32_16x16x32_bf16 v[64:67], v[128:131], v[196:199], v[64:67]
ds_read_b128 v[148:151], v213 offset:3584
v_mfma_f32_16x16x32_bf16 v[60:63], v[124:127], v[196:199], v[60:63]
s_waitcnt lgkmcnt(4)
ds_read_b64 v[108:109], v212 offset:3072
v_mfma_f32_16x16x32_bf16 v[64:67], v[124:127], v[200:203], v[64:67]
ds_read_b64 v[110:111], v212 offset:3080
v_mfma_f32_16x16x32_bf16 v[56:59], v[120:123], v[180:183], v[56:59]
ds_read_b128 v[152:155], v213 offset:3072
ds_read_b64 v[104:105], v212 offset:2560
v_mfma_f32_16x16x32_bf16 v[60:63], v[120:123], v[200:203], v[60:63]
s_waitcnt vmcnt(6)
s_barrier
buffer_atomic_add v3, v254, s[44:47], 0 offen sc1
buffer_load_dwordx4 v245, s[32:35], s71 offen offset:1024 lds
v_mfma_f32_16x16x32_bf16 v[64:67], v[120:123], v[204:207], v[64:67]
ds_read_b64 v[106:107], v212 offset:2568
v_mfma_f32_16x16x32_bf16 v[52:55], v[116:119], v[180:183], v[52:55]
ds_read_b128 v[156:159], v213 offset:2560
ds_read_b64 v[100:101], v212 offset:2048
v_mfma_f32_16x16x32_bf16 v[56:59], v[116:119], v[184:187], v[56:59]
ds_read_b64 v[102:103], v212 offset:2056
buffer_load_dwordx4 v246, s[32:35], s71 offen offset:2048 lds
v_mfma_f32_16x16x32_bf16 v[60:63], v[116:119], v[204:207], v[60:63]
s_waitcnt lgkmcnt(4)
ds_read_b128 v[160:163], v213 offset:2048
ds_read_b64 v[96:97], v212 offset:1536
v_mfma_f32_16x16x32_bf16 v[64:67], v[116:119], v[208:211], v[64:67]
ds_read_b64 v[98:99], v212 offset:1544
ds_read_b128 v[164:167], v213 offset:1536
v_mfma_f32_16x16x32_bf16 v[48:51], v[112:115], v[148:151], 0
ds_read_b64 v[92:93], v212 offset:1024
ds_read_b64_tr_b16 a[0:1], v248 offset:0
v_mfma_f32_16x16x32_bf16 v[44:47], v[108:111], v[148:151], 0
buffer_load_dwordx4 v247, s[32:35], s71 offen offset:3072 lds
ds_read_b64 v[94:95], v212 offset:1032
v_mfma_f32_16x16x32_bf16 v[48:51], v[108:111], v[152:155], v[48:51]
s_waitcnt lgkmcnt(7)
ds_read_b64_tr_b16 a[2:3], v248 offset:2048
ds_read_b64_tr_b16 a[4:5], v249 offset:0
v_mfma_f32_16x16x32_bf16 v[40:43], v[104:107], v[148:151], 0
ds_read_b64_tr_b16 a[6:7], v249 offset:2048
s_add_u32 s71, s71, 40960
v_mfma_f32_16x16x32_bf16 v[44:47], v[104:107], v[152:155], v[44:47]
ds_read_b64_tr_b16 a[8:9], v236 offset:0
s_sub_u32 s63, s71, 286720
v_mfma_f32_16x16x32_bf16 v[48:51], v[104:107], v[156:159], v[48:51]
ds_write_b128 v216, v[52:55] offset:0
v_mfma_f32_16x16x32_bf16 v[36:39], v[100:103], v[148:151], 0
ds_read_b128 v[168:171], v213 offset:1024
s_min_u32 s71, s71, s63
v_mfma_f32_16x16x32_bf16 v[40:43], v[100:103], v[152:155], v[40:43]
buffer_load_dwordx4 a[76:79], v7, s[44:47], s17 offen sc1
v_mfma_f32_16x16x32_bf16 v[44:47], v[100:103], v[156:159], v[44:47]
s_waitcnt lgkmcnt(3)
ds_write_b128 v216, v[56:59] offset:1024
v_mfma_f32_16x16x32_bf16 v[48:51], v[100:103], v[160:163], v[48:51]
ds_read_b64_tr_b16 a[10:11], v236 offset:2048
v_mfma_f32_16x16x32_bf16 v[32:35], v[96:99], v[148:151], 0
ds_read_b64 v[88:89], v212 offset:512
v_mfma_f32_16x16x32_bf16 v[36:39], v[96:99], v[152:155], v[36:39]
ds_write_b128 v216, v[60:63] offset:2048
v_mfma_f32_16x16x32_bf16 v[40:43], v[96:99], v[156:159], v[40:43]
ds_read_b64_tr_b16 a[12:13], v243 offset:0
v_mfma_f32_16x16x32_bf16 v[44:47], v[96:99], v[160:163], v[44:47]
ds_read_b64 v[90:91], v212 offset:520
v_mfma_f32_16x16x32_bf16 v[48:51], v[96:99], v[164:167], v[48:51]
ds_read_b64_tr_b16 a[14:15], v243 offset:2048
v_mfma_f32_16x16x32_bf16 v[28:31], v[92:95], v[148:151], 0
ds_write_b128 v216, v[64:67] offset:3072
v_mfma_f32_16x16x32_bf16 v[32:35], v[92:95], v[152:155], v[32:35]
ds_read_b128 v[172:175], v213 offset:512
v_mfma_f32_16x16x32_bf16 v[36:39], v[92:95], v[156:159], v[36:39]
ds_read_b64 v[84:85], v212 offset:0
ds_read_b64 v[86:87], v212 offset:8
v_mfma_f32_16x16x32_bf16 v[40:43], v[92:95], v[160:163], v[40:43]
ds_read_b128 v[176:179], v213 offset:0
ds_read_b64 v[144:145], v212 offset:3648
v_mfma_f32_16x16x32_bf16 v[44:47], v[92:95], v[164:167], v[44:47]
s_waitcnt lgkmcnt(6)
ds_read_b64 v[146:147], v212 offset:3656
ds_read_b128 v[180:183], v213 offset:3648
v_mfma_f32_16x16x32_bf16 v[48:51], v[92:95], v[168:171], v[48:51]
ds_read_b64_tr_b16 a[20:21], v248 offset:49152
ds_read_b64 v[140:141], v212 offset:3136
s_add_u32 m0, s70, 16384
v_mfma_f32_16x16x32_bf16 v[24:27], v[88:91], v[148:151], 0
s_nop 0
buffer_load_dwordx4 v244, s[32:35], s71 offen offset:0 lds
ds_read_b64 v[142:143], v212 offset:3144
v_mfma_f32_16x16x32_bf16 v[28:31], v[88:91], v[152:155], v[28:31]
s_waitcnt lgkmcnt(7)
s_barrier
ds_read_b64_tr_b16 a[22:23], v248 offset:51200
ds_read_b128 v[184:187], v213 offset:3136
v_mfma_f32_16x16x32_bf16 v[32:35], v[88:91], v[156:159], v[32:35]
buffer_load_dwordx4 v245, s[32:35], s71 offen offset:1024 lds
ds_read_b64_tr_b16 a[24:25], v249 offset:49152
v_mfma_f32_16x16x32_bf16 v[36:39], v[88:91], v[160:163], v[36:39]
buffer_store_dwordx4 a[252:255], v18, s[44:47], s18 offen sc1
v_mfma_f32_16x16x32_bf16 v[40:43], v[88:91], v[164:167], v[40:43]
ds_read_b64 v[136:137], v212 offset:2624
ds_read_b64_tr_b16 a[26:27], v249 offset:51200
v_mfma_f32_16x16x32_bf16 v[44:47], v[88:91], v[168:171], v[44:47]
ds_read_b64 v[138:139], v212 offset:2632
v_mfma_f32_16x16x32_bf16 v[48:51], v[88:91], v[172:175], v[48:51]
ds_read_b64_tr_b16 a[28:29], v236 offset:49152
ds_read_b128 v[188:191], v213 offset:2624
v_mfma_f32_16x16x32_bf16 v[20:23], v[84:87], v[148:151], 0
buffer_load_dwordx4 v246, s[32:35], s71 offen offset:2048 lds
ds_read_b64_tr_b16 a[30:31], v236 offset:51200
v_mfma_f32_16x16x32_bf16 v[24:27], v[84:87], v[152:155], v[24:27]
ds_read_b64 v[132:133], v212 offset:2112
ds_read_b64_tr_b16 a[32:33], v243 offset:49152
v_mfma_f32_16x16x32_bf16 v[28:31], v[84:87], v[156:159], v[28:31]
ds_read_b64 v[134:135], v212 offset:2120
v_mfma_f32_16x16x32_bf16 v[32:35], v[84:87], v[160:163], v[32:35]
ds_read_b64_tr_b16 a[34:35], v243 offset:51200
v_mfma_f32_16x16x32_bf16 v[36:39], v[84:87], v[164:167], v[36:39]
buffer_load_dwordx4 v247, s[32:35], s71 offen offset:3072 lds
v_mfma_f32_16x16x32_bf16 v[40:43], v[84:87], v[168:171], v[40:43]
ds_read_b128 v[192:195], v213 offset:2112
v_mfma_f32_16x16x32_bf16 v[44:47], v[84:87], v[172:175], v[44:47]
s_waitcnt lgkmcnt(3)
buffer_store_dwordx4 a[252:255], v18, s[44:47], s18 offen offset:1024 sc1
v_mfma_f32_16x16x32_bf16 v[48:51], v[84:87], v[176:179], v[48:51]
ds_read_b64 v[128:129], v212 offset:1600
s_add_u32 s71, s71, 40960
v_mfma_f32_16x16x32_bf16 v[48:51], v[144:147], v[180:183], v[48:51]
ds_read_b64 v[130:131], v212 offset:1608
s_sub_u32 s63, s71, 286720
v_mfma_f32_16x16x32_bf16 v[44:47], v[140:143], v[180:183], v[44:47]
ds_read_b128 v[68:71], v220 offset:0
s_min_u32 s71, s71, s63
v_mfma_f32_16x16x32_bf16 v[48:51], v[140:143], v[184:187], v[48:51]
s_waitcnt vmcnt(13)
buffer_load_dwordx4 a[96:99], v8, s[44:47], s17 offen sc1
v_mfma_f32_16x16x32_bf16 v[40:43], v[136:139], v[180:183], v[40:43]
s_waitcnt lgkmcnt(3)
ds_read_b128 v[196:199], v213 offset:1600
ds_read_b128 v[72:75], v220 offset:4096
v_mfma_f32_16x16x32_bf16 v[44:47], v[136:139], v[184:187], v[44:47]
ds_read_b64 v[124:125], v212 offset:1088
ds_read_b128 v[76:79], v220 offset:8192
v_mfma_f32_16x16x32_bf16 v[48:51], v[136:139], v[188:191], v[48:51]
ds_read_b64 v[126:127], v212 offset:1096
ds_read_b128 v[80:83], v220 offset:12288
v_mfma_f32_16x16x32_bf16 v[36:39], v[132:135], v[180:183], v[36:39]
ds_read_b128 v[200:203], v213 offset:1088
ds_read_b64 v[120:121], v212 offset:576
s_add_u32 m0, s70, 65536
v_mfma_f32_16x16x32_bf16 v[40:43], v[132:135], v[184:187], v[40:43]
s_nop 0
buffer_load_dwordx4 v244, s[32:35], s71 offen offset:0 lds
ds_read_b64_tr_b16 a[40:41], v248 offset:16384
v_mfma_f32_16x16x32_bf16 v[44:47], v[132:135], v[188:191], v[44:47]
buffer_store_dwordx2 a[252:253], v235, s[44:47], s18 offen offset:2048 sc1
v_mfma_f32_16x16x32_bf16 v[48:51], v[132:135], v[192:195], v[48:51]
s_waitcnt lgkmcnt(5)
buffer_load_dwordx4 v245, s[32:35], s71 offen offset:1024 lds
ds_read_b64 v[122:123], v212 offset:584
v_mfma_f32_16x16x32_bf16 v[32:35], v[128:131], v[180:183], v[32:35]
s_waitcnt lgkmcnt(4)
ds_read_b64_tr_b16 a[42:43], v248 offset:18432
v_add_f32 v68, v68, v72
v_mfma_f32_16x16x32_bf16 v[36:39], v[128:131], v[184:187], v[36:39]
ds_read_b64_tr_b16 a[44:45], v249 offset:16384
v_add_f32 v69, v69, v73
v_mfma_f32_16x16x32_bf16 v[40:43], v[128:131], v[188:191], v[40:43]
ds_read_b64_tr_b16 a[46:47], v249 offset:18432
v_add_f32 v70, v70, v74
v_mfma_f32_16x16x32_bf16 v[44:47], v[128:131], v[192:195], v[44:47]
ds_read_b64_tr_b16 a[48:49], v236 offset:16384
v_add_f32 v71, v71, v75
v_mfma_f32_16x16x32_bf16 v[48:51], v[128:131], v[196:199], v[48:51]
buffer_load_dwordx4 v246, s[32:35], s71 offen offset:2048 lds
v_mfma_f32_16x16x32_bf16 v[28:31], v[124:127], v[180:183], v[28:31]
ds_read_b64_tr_b16 a[50:51], v236 offset:18432
v_add_f32 v76, v76, v80
v_mfma_f32_16x16x32_bf16 v[32:35], v[124:127], v[184:187], v[32:35]
ds_read_b128 v[204:207], v213 offset:576
ds_read_b64_tr_b16 a[52:53], v243 offset:16384
v_mfma_f32_16x16x32_bf16 v[36:39], v[124:127], v[188:191], v[36:39]
ds_read_b64 v[116:117], v212 offset:64
v_add_f32 v77, v77, v81
v_mfma_f32_16x16x32_bf16 v[40:43], v[124:127], v[192:195], v[40:43]
ds_read_b64_tr_b16 a[54:55], v243 offset:18432
v_add_f32 v78, v78, v82
v_mfma_f32_16x16x32_bf16 v[44:47], v[124:127], v[196:199], v[44:47]
s_waitcnt lgkmcnt(5)
ds_read_b64 v[118:119], v212 offset:72
v_add_f32 v79, v79, v83
v_mfma_f32_16x16x32_bf16 v[48:51], v[124:127], v[200:203], v[48:51]
buffer_load_dwordx4 v247, s[32:35], s71 offen offset:3072 lds
v_mfma_f32_16x16x32_bf16 v[24:27], v[120:123], v[180:183], v[24:27]
buffer_store_dwordx4 a[252:255], v18, s[44:47], s16 offen offset:0 sc1
v_mfma_f32_16x16x32_bf16 v[28:31], v[120:123], v[184:187], v[28:31]
ds_read_b128 v[208:211], v213 offset:64
s_add_u32 s71, s71, 40960
v_mfma_f32_16x16x32_bf16 v[32:35], v[120:123], v[188:191], v[32:35]
s_waitcnt vmcnt(14)
ds_read_b64 v[112:113], v212 offset:3712
ds_read_b64 v[114:115], v212 offset:3720
v_mfma_f32_16x16x32_bf16 v[36:39], v[120:123], v[192:195], v[36:39]
ds_read_b128 v[148:151], v213 offset:3712
ds_read_b64 v[108:109], v212 offset:3200
s_sub_u32 s63, s71, 286720
v_mfma_f32_16x16x32_bf16 v[40:43], v[120:123], v[196:199], v[40:43]
ds_read_b64 v[110:111], v212 offset:3208
ds_read_b128 v[152:155], v213 offset:3200
s_min_u32 s71, s71, s63
v_mfma_f32_16x16x32_bf16 v[44:47], v[120:123], v[200:203], v[44:47]
s_waitcnt lgkmcnt(7)
buffer_load_dwordx4 a[116:119], v9, s[44:47], s17 offen sc1
ds_read_b64 v[104:105], v212 offset:2688
v_mfma_f32_16x16x32_bf16 v[48:51], v[120:123], v[204:207], v[48:51]
ds_read_b64 v[106:107], v212 offset:2696
ds_read_b128 v[156:159], v213 offset:2688
v_mfma_f32_16x16x32_bf16 v[20:23], v[116:119], v[180:183], v[20:23]
buffer_store_dwordx4 a[252:255], v18, s[44:47], s16 offen offset:1024 sc1
v_mfma_f32_16x16x32_bf16 v[24:27], v[116:119], v[184:187], v[24:27]
ds_read_b64 v[100:101], v212 offset:2176
ds_read_b64_tr_b16 a[60:61], v248 offset:32768
s_add_u32 m0, s70, 32768
v_mfma_f32_16x16x32_bf16 v[28:31], v[116:119], v[188:191], v[28:31]
s_nop 0
buffer_load_dwordx4 v244, s[32:35], s71 offen offset:0 lds
ds_read_b64 v[102:103], v212 offset:2184
v_mfma_f32_16x16x32_bf16 v[32:35], v[116:119], v[192:195], v[32:35]
ds_read_b64_tr_b16 a[62:63], v248 offset:34816
ds_read_b64_tr_b16 a[64:65], v249 offset:32768
v_mfma_f32_16x16x32_bf16 v[36:39], v[116:119], v[196:199], v[36:39]
buffer_load_dwordx4 v245, s[32:35], s71 offen offset:1024 lds
ds_read_b128 v[160:163], v213 offset:2176
v_mfma_f32_16x16x32_bf16 v[40:43], v[116:119], v[200:203], v[40:43]
ds_read_b64_tr_b16 a[66:67], v249 offset:34816
ds_read_b64 v[96:97], v212 offset:1664
v_mfma_f32_16x16x32_bf16 v[44:47], v[116:119], v[204:207], v[44:47]
s_waitcnt lgkmcnt(6)
ds_read_b64_tr_b16 a[68:69], v236 offset:32768
v_add_f32 v68, v68, v76
v_mfma_f32_16x16x32_bf16 v[48:51], v[116:119], v[208:211], v[48:51]
ds_read_b64 v[98:99], v212 offset:1672
v_add_f32 v69, v69, v77
v_mfma_f32_16x16x32_bf16 v[48:51], v[112:115], v[148:151], v[48:51]
ds_read_b64_tr_b16 a[70:71], v236 offset:34816
v_add_f32 v70, v70, v78
v_mfma_f32_16x16x32_bf16 v[44:47], v[108:111], v[148:151], v[44:47]
ds_read_b64_tr_b16 a[72:73], v243 offset:32768
v_add_f32 v71, v71, v79
v_mfma_f32_16x16x32_bf16 v[48:51], v[108:111], v[152:155], v[48:51]
buffer_load_dwordx4 v246, s[32:35], s71 offen offset:2048 lds
v_mfma_f32_16x16x32_bf16 v[40:43], v[104:107], v[148:151], v[40:43]
ds_read_b64_tr_b16 a[74:75], v243 offset:34816
v_cvt_pk_bf16_f32 v16, v68, v69
v_mfma_f32_16x16x32_bf16 v[44:47], v[104:107], v[152:155], v[44:47]
buffer_store_dwordx2 a[252:253], v221, s[44:47], 0 offen sc1
v_mfma_f32_16x16x32_bf16 v[48:51], v[104:107], v[156:159], v[48:51]
s_waitcnt lgkmcnt(2)
ds_read_b128 v[164:167], v213 offset:1664
v_cvt_pk_bf16_f32 v17, v70, v71
v_mfma_f32_16x16x32_bf16 v[36:39], v[100:103], v[148:151], v[36:39]
ds_read_b64 v[92:93], v212 offset:1152
v_mfma_f32_16x16x32_bf16 v[40:43], v[100:103], v[152:155], v[40:43]
ds_read_b64 v[94:95], v212 offset:1160
v_mfma_f32_16x16x32_bf16 v[44:47], v[100:103], v[156:159], v[44:47]
s_waitcnt vmcnt(14)
buffer_load_dwordx4 v247, s[32:35], s71 offen offset:3072 lds
v_mfma_f32_16x16x32_bf16 v[48:51], v[100:103], v[160:163], v[48:51]
ds_read_b128 v[168:171], v213 offset:1152
v_mfma_f32_16x16x32_bf16 v[32:35], v[96:99], v[148:151], v[32:35]
ds_read_b64 v[88:89], v212 offset:640
v_mfma_f32_16x16x32_bf16 v[36:39], v[96:99], v[152:155], v[36:39]
buffer_load_dwordx4 a[136:139], v10, s[44:47], s17 offen sc1
v_mfma_f32_16x16x32_bf16 v[40:43], v[96:99], v[156:159], v[40:43]
ds_read_b64 v[90:91], v212 offset:648
v_mfma_f32_16x16x32_bf16 v[44:47], v[96:99], v[160:163], v[44:47]
s_waitcnt lgkmcnt(3)
ds_read_b128 v[172:175], v213 offset:640
v_mfma_f32_16x16x32_bf16 v[48:51], v[96:99], v[164:167], v[48:51]
ds_read_b64_tr_b16 a[80:81], v248 offset:0
v_mfma_f32_16x16x32_bf16 v[28:31], v[92:95], v[148:151], v[28:31]
ds_read_b64 v[84:85], v212 offset:128
v_mfma_f32_16x16x32_bf16 v[32:35], v[92:95], v[152:155], v[32:35]
v_readfirstlane_b32 s24, v218
ds_read_b64_tr_b16 a[82:83], v248 offset:2048
v_mfma_f32_16x16x32_bf16 v[36:39], v[92:95], v[156:159], v[36:39]
ds_read_b64 v[86:87], v212 offset:136
v_mfma_f32_16x16x32_bf16 v[40:43], v[92:95], v[160:163], v[40:43]
ds_read_b64_tr_b16 a[84:85], v249 offset:0
v_mfma_f32_16x16x32_bf16 v[44:47], v[92:95], v[164:167], v[44:47]
s_waitcnt lgkmcnt(4)
ds_read_b64_tr_b16 a[86:87], v249 offset:2048
v_mfma_f32_16x16x32_bf16 v[48:51], v[92:95], v[168:171], v[48:51]
s_load_dword s20, s[44:45], s24
ds_read_b64_tr_b16 a[88:89], v236 offset:0
v_mfma_f32_16x16x32_bf16 v[24:27], v[88:91], v[148:151], v[24:27]
ds_read_b64_tr_b16 a[90:91], v236 offset:2048
v_mfma_f32_16x16x32_bf16 v[28:31], v[88:91], v[152:155], v[28:31]
ds_read_b64_tr_b16 a[92:93], v243 offset:0
v_mfma_f32_16x16x32_bf16 v[32:35], v[88:91], v[156:159], v[32:35]
ds_read_b128 v[176:179], v213 offset:128
v_mfma_f32_16x16x32_bf16 v[36:39], v[88:91], v[160:163], v[36:39]
ds_read_b64_tr_b16 a[94:95], v243 offset:2048
v_mfma_f32_16x16x32_bf16 v[40:43], v[88:91], v[164:167], v[40:43]
ds_read_b64 v[144:145], v212 offset:3776
v_mfma_f32_16x16x32_bf16 v[44:47], v[88:91], v[168:171], v[44:47]
ds_read_b64 v[146:147], v212 offset:3784
v_mfma_f32_16x16x32_bf16 v[48:51], v[88:91], v[172:175], v[48:51]
s_waitcnt lgkmcnt(4)
ds_read_b128 v[180:183], v213 offset:3776
v_mfma_f32_16x16x32_bf16 v[20:23], v[84:87], v[148:151], v[20:23]
ds_read_b64 v[140:141], v212 offset:3264
v_mfma_f32_16x16x32_bf16 v[24:27], v[84:87], v[152:155], v[24:27]
s_waitcnt vmcnt(9)
ds_read_b64 v[142:143], v212 offset:3272
ds_read_b128 v[184:187], v213 offset:3264
v_mfma_f32_16x16x32_bf16 v[28:31], v[84:87], v[156:159], v[28:31]
ds_read_b64 v[136:137], v212 offset:2752
ds_read_b64 v[138:139], v212 offset:2760
v_mfma_f32_16x16x32_bf16 v[32:35], v[84:87], v[160:163], v[32:35]
ds_read_b128 v[188:191], v213 offset:2752
v_mfma_f32_16x16x32_bf16 v[36:39], v[84:87], v[164:167], v[36:39]
ds_read_b64 v[132:133], v212 offset:2240
v_mfma_f32_16x16x32_bf16 v[40:43], v[84:87], v[168:171], v[40:43]
ds_read_b64 v[134:135], v212 offset:2248
v_mfma_f32_16x16x32_bf16 v[44:47], v[84:87], v[172:175], v[44:47]
s_waitcnt lgkmcnt(5)
ds_read_b128 v[192:195], v213 offset:2240
v_mfma_f32_16x16x32_bf16 v[48:51], v[84:87], v[176:179], v[48:51]
ds_read_b64 v[128:129], v212 offset:1728
v_mfma_f32_16x16x32_bf16 v[48:51], v[144:147], v[180:183], v[48:51]
ds_read_b64 v[130:131], v212 offset:1736
v_mfma_f32_16x16x32_bf16 v[44:47], v[140:143], v[180:183], v[44:47]
ds_read_b64_tr_b16 a[100:101], v248 offset:49152
v_mfma_f32_16x16x32_bf16 v[48:51], v[140:143], v[184:187], v[48:51]
s_waitcnt lgkmcnt(4)
ds_read_b64_tr_b16 a[102:103], v248 offset:51200
v_mfma_f32_16x16x32_bf16 v[40:43], v[136:139], v[180:183], v[40:43]
ds_read_b128 v[196:199], v213 offset:1728
v_mfma_f32_16x16x32_bf16 v[44:47], v[136:139], v[184:187], v[44:47]
ds_read_b64_tr_b16 a[104:105], v249 offset:49152
v_mfma_f32_16x16x32_bf16 v[48:51], v[136:139], v[188:191], v[48:51]
ds_read_b64 v[124:125], v212 offset:1216
v_mfma_f32_16x16x32_bf16 v[36:39], v[132:135], v[180:183], v[36:39]
ds_read_b64_tr_b16 a[106:107], v249 offset:51200
v_mfma_f32_16x16x32_bf16 v[40:43], v[132:135], v[184:187], v[40:43]
ds_read_b64 v[126:127], v212 offset:1224
v_mfma_f32_16x16x32_bf16 v[44:47], v[132:135], v[188:191], v[44:47]
s_waitcnt lgkmcnt(4)
ds_read_b64_tr_b16 a[108:109], v236 offset:49152
v_mfma_f32_16x16x32_bf16 v[48:51], v[132:135], v[192:195], v[48:51]
ds_read_b64_tr_b16 a[110:111], v236 offset:51200
v_mfma_f32_16x16x32_bf16 v[32:35], v[128:131], v[180:183], v[32:35]
ds_read_b64_tr_b16 a[112:113], v243 offset:49152
v_mfma_f32_16x16x32_bf16 v[36:39], v[128:131], v[184:187], v[36:39]
ds_read_b64_tr_b16 a[114:115], v243 offset:51200
v_mfma_f32_16x16x32_bf16 v[40:43], v[128:131], v[188:191], v[40:43]
ds_read_b128 v[200:203], v213 offset:1216
v_mfma_f32_16x16x32_bf16 v[44:47], v[128:131], v[192:195], v[44:47]
ds_read_b64 v[120:121], v212 offset:704
v_mfma_f32_16x16x32_bf16 v[48:51], v[128:131], v[196:199], v[48:51]
s_waitcnt lgkmcnt(0)
s_cmp_eq_u32 s20, 7
s_cbranch_scc0 LS_f20
LR_f20:
ds_read_b64 v[122:123], v212 offset:712
buffer_load_dwordx4 a[140:143], v4, s[44:47], s8 offen sc1
v_mfma_f32_16x16x32_bf16 v[28:31], v[124:127], v[180:183], v[28:31]
s_waitcnt vmcnt(2)
ds_read_b128 v[204:207], v213 offset:704
ds_read_b64 v[116:117], v212 offset:192
v_mfma_f32_16x16x32_bf16 v[32:35], v[124:127], v[184:187], v[32:35]
buffer_load_dwordx4 a[144:147], v5, s[44:47], s8 offen sc1
ds_read_b64 v[118:119], v212 offset:200
v_mfma_f32_16x16x32_bf16 v[36:39], v[124:127], v[188:191], v[36:39]
ds_read_b64_tr_b16 a[120:121], v248 offset:16384
v_mfma_f32_16x16x32_bf16 v[40:43], v[124:127], v[192:195], v[40:43]
buffer_load_dwordx4 a[148:151], v6, s[44:47], s8 offen sc1
v_mfma_f32_16x16x32_bf16 v[44:47], v[124:127], v[196:199], v[44:47]
ds_read_b64_tr_b16 a[122:123], v248 offset:18432
v_mfma_f32_16x16x32_bf16 v[48:51], v[124:127], v[200:203], v[48:51]
s_waitcnt lgkmcnt(3)
buffer_load_dwordx4 a[152:155], v7, s[44:47], s8 offen sc1
v_mfma_f32_16x16x32_bf16 v[24:27], v[120:123], v[180:183], v[24:27]
ds_read_b64_tr_b16 a[124:125], v249 offset:16384
v_mfma_f32_16x16x32_bf16 v[28:31], v[120:123], v[184:187], v[28:31]
buffer_load_dwordx4 a[156:159], v8, s[44:47], s8 offen sc1
v_mfma_f32_16x16x32_bf16 v[32:35], v[120:123], v[188:191], v[32:35]
ds_read_b128 v[208:211], v213 offset:192
v_mfma_f32_16x16x32_bf16 v[36:39], v[120:123], v[192:195], v[36:39]
buffer_load_dwordx4 a[160:163], v9, s[44:47], s8 offen sc1
v_mfma_f32_16x16x32_bf16 v[40:43], v[120:123], v[196:199], v[40:43]
ds_read_b64_tr_b16 a[126:127], v249 offset:18432
v_mfma_f32_16x16x32_bf16 v[44:47], v[120:123], v[200:203], v[44:47]
buffer_load_dwordx4 a[164:167], v10, s[44:47], s8 offen sc1
v_mfma_f32_16x16x32_bf16 v[48:51], v[120:123], v[204:207], v[48:51]
s_waitcnt lgkmcnt(2)
ds_read_b64_tr_b16 a[128:129], v236 offset:16384
v_mfma_f32_16x16x32_bf16 v[20:23], v[116:119], v[180:183], v[20:23]
buffer_load_dwordx4 a[168:171], v4, s[44:47], s9 offen sc1
v_mfma_f32_16x16x32_bf16 v[24:27], v[116:119], v[184:187], v[24:27]
ds_read_b64_tr_b16 a[130:131], v236 offset:18432
v_mfma_f32_16x16x32_bf16 v[28:31], v[116:119], v[188:191], v[28:31]
buffer_load_dwordx4 a[172:175], v5, s[44:47], s9 offen sc1
v_mfma_f32_16x16x32_bf16 v[32:35], v[116:119], v[192:195], v[32:35]
ds_read_b64_tr_b16 a[132:133], v243 offset:16384
v_mfma_f32_16x16x32_bf16 v[36:39], v[116:119], v[196:199], v[36:39]
ds_read_b64_tr_b16 a[134:135], v243 offset:18432
v_mfma_f32_16x16x32_bf16 v[40:43], v[116:119], v[200:203], v[40:43]
buffer_load_dwordx4 a[176:179], v6, s[44:47], s9 offen sc1
v_mfma_f32_16x16x32_bf16 v[44:47], v[116:119], v[204:207], v[44:47]
s_waitcnt lgkmcnt(2)
v_mfma_f32_16x16x32_bf16 v[48:51], v[116:119], v[208:211], v[48:51]
s_branch LC_end
LC_m1:
ds_read_b64 v[104:105], v214 offset:2560
ds_read_b64 v[106:107], v214 offset:2568
ds_read_b128 v[148:151], v215 offset:3584
ds_read_b64 v[100:101], v214 offset:2048
ds_read_b64 v[102:103], v214 offset:2056
ds_read_b128 v[152:155], v215 offset:3072
ds_read_b64 v[96:97], v214 offset:1536
ds_read_b64 v[98:99], v214 offset:1544
ds_read_b128 v[156:159], v215 offset:2560
s_waitcnt lgkmcnt(6)
v_mfma_f32_16x16x32_bf16 v[64:67], v[104:107], v[148:151], 0
s_waitcnt lgkmcnt(4)
ds_read_b64 v[92:93], v214 offset:1024
ds_read_b64 v[94:95], v214 offset:1032
v_mfma_f32_16x16x32_bf16 v[60:63], v[100:103], v[148:151], 0
s_waitcnt lgkmcnt(5)
ds_read_b128 v[160:163], v215 offset:2048
ds_read_b64 v[88:89], v214 offset:512
v_mfma_f32_16x16x32_bf16 v[64:67], v[100:103], v[152:155], v[64:67]
s_waitcnt lgkmcnt(5)
ds_read_b64 v[90:91], v214 offset:520
ds_read_b128 v[164:167], v215 offset:1536
v_mfma_f32_16x16x32_bf16 v[56:59], v[96:99], v[148:151], 0
ds_read_b64 v[84:85], v214 offset:0
ds_read_b64 v[86:87], v214 offset:8
s_add_u32 m0, s70, 32768
v_mfma_f32_16x16x32_bf16 v[60:63], v[96:99], v[152:155], v[60:63]
s_waitcnt lgkmcnt(8)
ds_read_b128 v[168:171], v215 offset:1024
ds_read_b64 v[136:137], v214 offset:2624
s_nop 0
v_mfma_f32_16x16x32_bf16 v[64:67], v[96:99], v[156:159], v[64:67]
s_waitcnt lgkmcnt(8)
buffer_load_dwordx4 v244, s[32:35], s71 offen offset:0 lds
v_mfma_f32_16x16x32_bf16 v[52:55], v[92:95], v[148:151], 0
ds_read_b64 v[138:139], v214 offset:2632
v_mfma_f32_16x16x32_bf16 v[56:59], v[92:95], v[152:155], v[56:59]
buffer_load_dwordx4 v245, s[32:35], s71 offen offset:1024 lds
v_mfma_f32_16x16x32_bf16 v[60:63], v[92:95], v[156:159], v[60:63]
s_waitcnt lgkmcnt(3)
ds_read_b128 v[180:183], v215 offset:3648
v_mfma_f32_16x16x32_bf16 v[64:67], v[92:95], v[160:163], v[64:67]
ds_read_b64 v[132:133], v214 offset:2112
v_mfma_f32_16x16x32_bf16 v[52:55], v[88:91], v[152:155], v[52:55]
ds_read_b64 v[134:135], v214 offset:2120
v_mfma_f32_16x16x32_bf16 v[56:59], v[88:91], v[156:159], v[56:59]
ds_read_b128 v[184:187], v215 offset:3136
v_mfma_f32_16x16x32_bf16 v[60:63], v[88:91], v[160:163], v[60:63]
ds_read_b64 v[128:129], v214 offset:1600
v_mfma_f32_16x16x32_bf16 v[64:67], v[88:91], v[164:167], v[64:67]
ds_read_b64 v[130:131], v214 offset:1608
v_mfma_f32_16x16x32_bf16 v[52:55], v[84:87], v[156:159], v[52:55]
buffer_load_dwordx4 v246, s[32:35], s71 offen offset:2048 lds
ds_read_b128 v[188:191], v215 offset:2624
v_mfma_f32_16x16x32_bf16 v[56:59], v[84:87], v[160:163], v[56:59]
ds_read_b64 v[124:125], v214 offset:1088
v_mfma_f32_16x16x32_bf16 v[60:63], v[84:87], v[164:167], v[60:63]
s_waitcnt lgkmcnt(4)
ds_read_b64 v[126:127], v214 offset:1096
buffer_load_dwordx4 v247, s[32:35], s71 offen offset:3072 lds
v_mfma_f32_16x16x32_bf16 v[64:67], v[84:87], v[168:171], v[64:67]
ds_read_b128 v[192:195], v215 offset:2112
s_add_u32 s71, s71, 40960
v_mfma_f32_16x16x32_bf16 v[64:67], v[136:139], v[180:183], v[64:67]
ds_read_b64 v[120:121], v214 offset:576
s_sub_u32 s63, s71, 286720
v_mfma_f32_16x16x32_bf16 v[60:63], v[132:135], v[180:183], v[60:63]
ds_read_b64 v[122:123], v214 offset:584
s_min_u32 s71, s71, s63
v_mfma_f32_16x16x32_bf16 v[64:67], v[132:135], v[184:187], v[64:67]
s_waitcnt lgkmcnt(4)
ds_read_b128 v[196:199], v215 offset:1600
v_mfma_f32_16x16x32_bf16 v[56:59], v[128:131], v[180:183], v[56:59]
buffer_load_dwordx4 a[56:59], v6, s[44:47], s17 offen sc1
v_mfma_f32_16x16x32_bf16 v[60:63], v[128:131], v[184:187], v[60:63]
ds_read_b64 v[116:117], v214 offset:64
ds_read_b64 v[118:119], v214 offset:72
v_mfma_f32_16x16x32_bf16 v[64:67], v[128:131], v[188:191], v[64:67]
s_waitcnt lgkmcnt(4)
ds_read_b128 v[200:203], v215 offset:1088
ds_read_b64 v[112:113], v212 offset:3584
v_mfma_f32_16x16x32_bf16 v[52:55], v[124:127], v[180:183], v[52:55]
ds_read_b64 v[114:115], v212 offset:3592
s_add_u32 m0, s70, 49152
v_mfma_f32_16x16x32_bf16 v[56:59], v[124:127], v[184:187], v[56:59]
s_nop 0
buffer_load_dwordx4 v244, s[32:35], s71 offen offset:0 lds
v_mfma_f32_16x16x32_bf16 v[60:63], v[124:127], v[188:191], v[60:63]
ds_read_b128 v[148:151], v213 offset:3584
v_mfma_f32_16x16x32_bf16 v[64:67], v[124:127], v[192:195], v[64:67]
s_waitcnt lgkmcnt(4)
ds_read_b64 v[108:109], v212 offset:3072
v_mfma_f32_16x16x32_bf16 v[52:55], v[120:123], v[184:187], v[52:55]
ds_read_b64 v[110:111], v212 offset:3080
v_mfma_f32_16x16x32_bf16 v[56:59], v[120:123], v[188:191], v[56:59]
ds_read_b128 v[152:155], v213 offset:3072
ds_read_b64 v[104:105], v212 offset:2560
v_mfma_f32_16x16x32_bf16 v[60:63], v[120:123], v[192:195], v[60:63]
s_waitcnt vmcnt(6)
s_barrier
buffer_atomic_add v3, v254, s[44:47], 0 offen sc1
buffer_load_dwordx4 v245, s[32:35], s71 offen offset:1024 lds
v_mfma_f32_16x16x32_bf16 v[64:67], v[120:123], v[196:199], v[64:67]
ds_read_b64 v[106:107], v212 offset:2568
v_mfma_f32_16x16x32_bf16 v[52:55], v[116:119], v[188:191], v[52:55]
ds_read_b128 v[156:159], v213 offset:2560
ds_read_b64 v[100:101], v212 offset:2048
v_mfma_f32_16x16x32_bf16 v[56:59], v[116:119], v[192:195], v[56:59]
ds_read_b64 v[102:103], v212 offset:2056
buffer_load_dwordx4 v246, s[32:35], s71 offen offset:2048 lds
v_mfma_f32_16x16x32_bf16 v[60:63], v[116:119], v[196:199], v[60:63]
s_waitcnt lgkmcnt(4)
ds_read_b128 v[160:163], v213 offset:2048
ds_read_b64 v[96:97], v212 offset:1536
v_mfma_f32_16x16x32_bf16 v[64:67], v[116:119], v[200:203], v[64:67]
ds_read_b64 v[98:99], v212 offset:1544
ds_read_b128 v[164:167], v213 offset:1536
v_mfma_f32_16x16x32_bf16 v[48:51], v[112:115], v[148:151], 0
ds_read_b64 v[92:93], v212 offset:1024
ds_read_b64_tr_b16 a[0:1], v248 offset:0
v_mfma_f32_16x16x32_bf16 v[44:47], v[108:111], v[148:151], 0
buffer_load_dwordx4 v247, s[32:35], s71 offen offset:3072 lds
ds_read_b64 v[94:95], v212 offset:1032
v_mfma_f32_16x16x32_bf16 v[48:51], v[108:111], v[152:155], v[48:51]
s_waitcnt lgkmcnt(7)
ds_read_b64_tr_b16 a[2:3], v248 offset:2048
ds_read_b64_tr_b16 a[4:5], v249 offset:0
v_mfma_f32_16x16x32_bf16 v[40:43], v[104:107], v[148:151], 0
ds_read_b64_tr_b16 a[6:7], v249 offset:2048
s_add_u32 s71, s71, 40960
v_mfma_f32_16x16x32_bf16 v[44:47], v[104:107], v[152:155], v[44:47]
ds_read_b64_tr_b16 a[8:9], v236 offset:0
s_sub_u32 s63, s71, 286720
v_mfma_f32_16x16x32_bf16 v[48:51], v[104:107], v[156:159], v[48:51]
ds_write_b128 v216, v[52:55] offset:0
v_mfma_f32_16x16x32_bf16 v[36:39], v[100:103], v[148:151], 0
ds_read_b128 v[168:171], v213 offset:1024
s_min_u32 s71, s71, s63
v_mfma_f32_16x16x32_bf16 v[40:43], v[100:103], v[152:155], v[40:43]
buffer_load_dwordx4 a[76:79], v7, s[44:47], s17 offen sc1
v_mfma_f32_16x16x32_bf16 v[44:47], v[100:103], v[156:159], v[44:47]
s_waitcnt lgkmcnt(3)
ds_write_b128 v216, v[56:59] offset:1024
v_mfma_f32_16x16x32_bf16 v[48:51], v[100:103], v[160:163], v[48:51]
ds_read_b64_tr_b16 a[10:11], v236 offset:2048
v_mfma_f32_16x16x32_bf16 v[32:35], v[96:99], v[148:151], 0
ds_read_b64 v[88:89], v212 offset:512
v_mfma_f32_16x16x32_bf16 v[36:39], v[96:99], v[152:155], v[36:39]
ds_write_b128 v216, v[60:63] offset:2048
v_mfma_f32_16x16x32_bf16 v[40:43], v[96:99], v[156:159], v[40:43]
ds_read_b64_tr_b16 a[12:13], v243 offset:0
v_mfma_f32_16x16x32_bf16 v[44:47], v[96:99], v[160:163], v[44:47]
ds_read_b64 v[90:91], v212 offset:520
v_mfma_f32_16x16x32_bf16 v[48:51], v[96:99], v[164:167], v[48:51]
ds_read_b64_tr_b16 a[14:15], v243 offset:2048
v_mfma_f32_16x16x32_bf16 v[28:31], v[92:95], v[148:151], 0
ds_write_b128 v216, v[64:67] offset:3072
v_mfma_f32_16x16x32_bf16 v[32:35], v[92:95], v[152:155], v[32:35]
ds_read_b128 v[172:175], v213 offset:512
v_mfma_f32_16x16x32_bf16 v[36:39], v[92:95], v[156:159], v[36:39]
ds_read_b64 v[84:85], v212 offset:0
ds_read_b64 v[86:87], v212 offset:8
v_mfma_f32_16x16x32_bf16 v[40:43], v[92:95], v[160:163], v[40:43]
ds_read_b128 v[176:179], v213 offset:0
ds_read_b64 v[144:145], v212 offset:3648
v_mfma_f32_16x16x32_bf16 v[44:47], v[92:95], v[164:167], v[44:47]
s_waitcnt lgkmcnt(6)
ds_read_b64 v[146:147], v212 offset:3656
ds_read_b128 v[180:183], v213 offset:3648
v_mfma_f32_16x16x32_bf16 v[48:51], v[92:95], v[168:171], v[48:51]
ds_read_b64_tr_b16 a[20:21], v248 offset:49152
ds_read_b64 v[140:141], v212 offset:3136
s_add_u32 m0, s70, 16384
v_mfma_f32_16x16x32_bf16 v[24:27], v[88:91], v[148:151], 0
s_nop 0
buffer_load_dwordx4 v244, s[32:35], s71 offen offset:0 lds
ds_read_b64 v[142:143], v212 offset:3144
v_mfma_f32_16x16x32_bf16 v[28:31], v[88:91], v[152:155], v[28:31]
s_waitcnt lgkmcnt(7)
s_barrier
ds_read_b64_tr_b16 a[22:23], v248 offset:51200
ds_read_b128 v[184:187], v213 offset:3136
v_mfma_f32_16x16x32_bf16 v[32:35], v[88:91], v[156:159], v[32:35]
buffer_load_dwordx4 v245, s[32:35], s71 offen offset:1024 lds
ds_read_b64_tr_b16 a[24:25], v249 offset:49152
v_mfma_f32_16x16x32_bf16 v[36:39], v[88:91], v[160:163], v[36:39]
buffer_store_dwordx4 a[252:255], v18, s[44:47], s18 offen sc1
v_mfma_f32_16x16x32_bf16 v[40:43], v[88:91], v[164:167], v[40:43]
ds_read_b64 v[136:137], v212 offset:2624
ds_read_b64_tr_b16 a[26:27], v249 offset:51200
v_mfma_f32_16x16x32_bf16 v[44:47], v[88:91], v[168:171], v[44:47]
ds_read_b64 v[138:139], v212 offset:2632
v_mfma_f32_16x16x32_bf16 v[48:51], v[88:91], v[172:175], v[48:51]
ds_read_b64_tr_b16 a[28:29], v236 offset:49152
ds_read_b128 v[188:191], v213 offset:2624
v_mfma_f32_16x16x32_bf16 v[20:23], v[84:87], v[148:151], 0
buffer_load_dwordx4 v246, s[32:35], s71 offen offset:2048 lds
ds_read_b64_tr_b16 a[30:31], v236 offset:51200
v_mfma_f32_16x16x32_bf16 v[24:27], v[84:87], v[152:155], v[24:27]
ds_read_b64 v[132:133], v212 offset:2112
ds_read_b64_tr_b16 a[32:33], v243 offset:49152
v_mfma_f32_16x16x32_bf16 v[28:31], v[84:87], v[156:159], v[28:31]
ds_read_b64 v[134:135], v212 offset:2120
v_mfma_f32_16x16x32_bf16 v[32:35], v[84:87], v[160:163], v[32:35]
ds_read_b64_tr_b16 a[34:35], v243 offset:51200
v_mfma_f32_16x16x32_bf16 v[36:39], v[84:87], v[164:167], v[36:39]
buffer_load_dwordx4 v247, s[32:35], s71 offen offset:3072 lds
v_mfma_f32_16x16x32_bf16 v[40:43], v[84:87], v[168:171], v[40:43]
ds_read_b128 v[192:195], v213 offset:2112
v_mfma_f32_16x16x32_bf16 v[44:47], v[84:87], v[172:175], v[44:47]
s_waitcnt lgkmcnt(3)
buffer_store_dwordx4 a[252:255], v18, s[44:47], s18 offen offset:1024 sc1
v_mfma_f32_16x16x32_bf16 v[48:51], v[84:87], v[176:179], v[48:51]
ds_read_b64 v[128:129], v212 offset:1600
s_add_u32 s71, s71, 40960
v_mfma_f32_16x16x32_bf16 v[48:51], v[144:147], v[180:183], v[48:51]
ds_read_b64 v[130:131], v212 offset:1608
s_sub_u32 s63, s71, 286720
v_mfma_f32_16x16x32_bf16 v[44:47], v[140:143], v[180:183], v[44:47]
ds_read_b128 v[68:71], v220 offset:0
s_min_u32 s71, s71, s63
v_mfma_f32_16x16x32_bf16 v[48:51], v[140:143], v[184:187], v[48:51]
s_waitcnt vmcnt(13)
buffer_load_dwordx4 a[96:99], v8, s[44:47], s17 offen sc1
v_mfma_f32_16x16x32_bf16 v[40:43], v[136:139], v[180:183], v[40:43]
s_waitcnt lgkmcnt(3)
ds_read_b128 v[196:199], v213 offset:1600
ds_read_b128 v[72:75], v220 offset:4096
v_mfma_f32_16x16x32_bf16 v[44:47], v[136:139], v[184:187], v[44:47]
ds_read_b64 v[124:125], v212 offset:1088
ds_read_b128 v[76:79], v220 offset:8192
v_mfma_f32_16x16x32_bf16 v[48:51], v[136:139], v[188:191], v[48:51]
ds_read_b64 v[126:127], v212 offset:1096
ds_read_b128 v[80:83], v220 offset:12288
v_mfma_f32_16x16x32_bf16 v[36:39], v[132:135], v[180:183], v[36:39]
ds_read_b128 v[200:203], v213 offset:1088
ds_read_b64 v[120:121], v212 offset:576
s_add_u32 m0, s70, 65536
v_mfma_f32_16x16x32_bf16 v[40:43], v[132:135], v[184:187], v[40:43]
s_nop 0
buffer_load_dwordx4 v244, s[32:35], s71 offen offset:0 lds
ds_read_b64_tr_b16 a[40:41], v248 offset:16384
v_mfma_f32_16x16x32_bf16 v[44:47], v[132:135], v[188:191], v[44:47]
buffer_store_dwordx2 a[252:253], v235, s[44:47], s18 offen offset:2048 sc1
v_mfma_f32_16x16x32_bf16 v[48:51], v[132:135], v[192:195], v[48:51]
s_waitcnt lgkmcnt(5)
buffer_load_dwordx4 v245, s[32:35], s71 offen offset:1024 lds
ds_read_b64 v[122:123], v212 offset:584
v_mfma_f32_16x16x32_bf16 v[32:35], v[128:131], v[180:183], v[32:35]
s_waitcnt lgkmcnt(4)
ds_read_b64_tr_b16 a[42:43], v248 offset:18432
v_add_f32 v68, v68, v72
v_mfma_f32_16x16x32_bf16 v[36:39], v[128:131], v[184:187], v[36:39]
ds_read_b64_tr_b16 a[44:45], v249 offset:16384
v_add_f32 v69, v69, v73
v_mfma_f32_16x16x32_bf16 v[40:43], v[128:131], v[188:191], v[40:43]
ds_read_b64_tr_b16 a[46:47], v249 offset:18432
v_add_f32 v70, v70, v74
v_mfma_f32_16x16x32_bf16 v[44:47], v[128:131], v[192:195], v[44:47]
ds_read_b64_tr_b16 a[48:49], v236 offset:16384
v_add_f32 v71, v71, v75
v_mfma_f32_16x16x32_bf16 v[48:51], v[128:131], v[196:199], v[48:51]
buffer_load_dwordx4 v246, s[32:35], s71 offen offset:2048 lds
v_mfma_f32_16x16x32_bf16 v[28:31], v[124:127], v[180:183], v[28:31]
ds_read_b64_tr_b16 a[50:51], v236 offset:18432
v_add_f32 v76, v76, v80
v_mfma_f32_16x16x32_bf16 v[32:35], v[124:127], v[184:187], v[32:35]
ds_read_b128 v[204:207], v213 offset:576
ds_read_b64_tr_b16 a[52:53], v243 offset:16384
v_mfma_f32_16x16x32_bf16 v[36:39], v[124:127], v[188:191], v[36:39]
ds_read_b64 v[116:117], v212 offset:64
v_add_f32 v77, v77, v81
v_mfma_f32_16x16x32_bf16 v[40:43], v[124:127], v[192:195], v[40:43]
ds_read_b64_tr_b16 a[54:55], v243 offset:18432
v_add_f32 v78, v78, v82
v_mfma_f32_16x16x32_bf16 v[44:47], v[124:127], v[196:199], v[44:47]
s_waitcnt lgkmcnt(5)
ds_read_b64 v[118:119], v212 offset:72
v_add_f32 v79, v79, v83
v_mfma_f32_16x16x32_bf16 v[48:51], v[124:127], v[200:203], v[48:51]
buffer_load_dwordx4 v247, s[32:35], s71 offen offset:3072 lds
v_mfma_f32_16x16x32_bf16 v[24:27], v[120:123], v[180:183], v[24:27]
buffer_store_dwordx4 a[252:255], v18, s[44:47], s16 offen offset:0 sc1
v_mfma_f32_16x16x32_bf16 v[28:31], v[120:123], v[184:187], v[28:31]
ds_read_b128 v[208:211], v213 offset:64
s_add_u32 s71, s71, 40960
v_mfma_f32_16x16x32_bf16 v[32:35], v[120:123], v[188:191], v[32:35]
s_waitcnt vmcnt(14)
ds_read_b64 v[112:113], v212 offset:3712
ds_read_b64 v[114:115], v212 offset:3720
v_mfma_f32_16x16x32_bf16 v[36:39], v[120:123], v[192:195], v[36:39]
ds_read_b128 v[148:151], v213 offset:3712
ds_read_b64 v[108:109], v212 offset:3200
s_sub_u32 s63, s71, 286720
v_mfma_f32_16x16x32_bf16 v[40:43], v[120:123], v[196:199], v[40:43]
ds_read_b64 v[110:111], v212 offset:3208
ds_read_b128 v[152:155], v213 offset:3200
s_min_u32 s71, s71, s63
v_mfma_f32_16x16x32_bf16 v[44:47], v[120:123], v[200:203], v[44:47]
s_waitcnt lgkmcnt(7)
buffer_load_dwordx4 a[116:119], v9, s[44:47], s17 offen sc1
ds_read_b64 v[104:105], v212 offset:2688
v_mfma_f32_16x16x32_bf16 v[48:51], v[120:123], v[204:207], v[48:51]
ds_read_b64 v[106:107], v212 offset:2696
ds_read_b128 v[156:159], v213 offset:2688
v_mfma_f32_16x16x32_bf16 v[20:23], v[116:119], v[180:183], v[20:23]
buffer_store_dwordx4 a[252:255], v18, s[44:47], s16 offen offset:1024 sc1
v_mfma_f32_16x16x32_bf16 v[24:27], v[116:119], v[184:187], v[24:27]
ds_read_b64 v[100:101], v212 offset:2176
ds_read_b64_tr_b16 a[60:61], v248 offset:32768
s_add_u32 m0, s70, 32768
v_mfma_f32_16x16x32_bf16 v[28:31], v[116:119], v[188:191], v[28:31]
s_nop 0
buffer_load_dwordx4 v244, s[32:35], s71 offen offset:0 lds
ds_read_b64 v[102:103], v212 offset:2184
v_mfma_f32_16x16x32_bf16 v[32:35], v[116:119], v[192:195], v[32:35]
ds_read_b64_tr_b16 a[62:63], v248 offset:34816
ds_read_b64_tr_b16 a[64:65], v249 offset:32768
v_mfma_f32_16x16x32_bf16 v[36:39], v[116:119], v[196:199], v[36:39]
buffer_load_dwordx4 v245, s[32:35], s71 offen offset:1024 lds
ds_read_b128 v[160:163], v213 offset:2176
v_mfma_f32_16x16x32_bf16 v[40:43], v[116:119], v[200:203], v[40:43]
ds_read_b64_tr_b16 a[66:67], v249 offset:34816
ds_read_b64 v[96:97], v212 offset:1664
v_mfma_f32_16x16x32_bf16 v[44:47], v[116:119], v[204:207], v[44:47]
s_waitcnt lgkmcnt(6)
ds_read_b64_tr_b16 a[68:69], v236 offset:32768
v_add_f32 v68, v68, v76
v_mfma_f32_16x16x32_bf16 v[48:51], v[116:119], v[208:211], v[48:51]
ds_read_b64 v[98:99], v212 offset:1672
v_add_f32 v69, v69, v77
v_mfma_f32_16x16x32_bf16 v[48:51], v[112:115], v[148:151], v[48:51]
ds_read_b64_tr_b16 a[70:71], v236 offset:34816
v_add_f32 v70, v70, v78
v_mfma_f32_16x16x32_bf16 v[44:47], v[108:111], v[148:151], v[44:47]
ds_read_b64_tr_b16 a[72:73], v243 offset:32768
v_add_f32 v71, v71, v79
v_mfma_f32_16x16x32_bf16 v[48:51], v[108:111], v[152:155], v[48:51]
buffer_load_dwordx4 v246, s[32:35], s71 offen offset:2048 lds
v_mfma_f32_16x16x32_bf16 v[40:43], v[104:107], v[148:151], v[40:43]
ds_read_b64_tr_b16 a[74:75], v243 offset:34816
v_cvt_pk_bf16_f32 v16, v68, v69
v_mfma_f32_16x16x32_bf16 v[44:47], v[104:107], v[152:155], v[44:47]
buffer_store_dwordx2 a[252:253], v221, s[44:47], 0 offen sc1
v_mfma_f32_16x16x32_bf16 v[48:51], v[104:107], v[156:159], v[48:51]
s_waitcnt lgkmcnt(2)
ds_read_b128 v[164:167], v213 offset:1664
v_cvt_pk_bf16_f32 v17, v70, v71
v_mfma_f32_16x16x32_bf16 v[36:39], v[100:103], v[148:151], v[36:39]
ds_read_b64 v[92:93], v212 offset:1152
v_mfma_f32_16x16x32_bf16 v[40:43], v[100:103], v[152:155], v[40:43]
ds_read_b64 v[94:95], v212 offset:1160
v_mfma_f32_16x16x32_bf16 v[44:47], v[100:103], v[156:159], v[44:47]
s_waitcnt vmcnt(14)
buffer_load_dwordx4 v247, s[32:35], s71 offen offset:3072 lds
v_mfma_f32_16x16x32_bf16 v[48:51], v[100:103], v[160:163], v[48:51]
ds_read_b128 v[168:171], v213 offset:1152
v_mfma_f32_16x16x32_bf16 v[32:35], v[96:99], v[148:151], v[32:35]
ds_read_b64 v[88:89], v212 offset:640
v_mfma_f32_16x16x32_bf16 v[36:39], v[96:99], v[152:155], v[36:39]
buffer_load_dwordx4 a[136:139], v10, s[44:47], s17 offen sc1
v_mfma_f32_16x16x32_bf16 v[40:43], v[96:99], v[156:159], v[40:43]
ds_read_b64 v[90:91], v212 offset:648
v_mfma_f32_16x16x32_bf16 v[44:47], v[96:99], v[160:163], v[44:47]
s_waitcnt lgkmcnt(3)
ds_read_b128 v[172:175], v213 offset:640
v_mfma_f32_16x16x32_bf16 v[48:51], v[96:99], v[164:167], v[48:51]
ds_read_b64_tr_b16 a[80:81], v248 offset:0
v_mfma_f32_16x16x32_bf16 v[28:31], v[92:95], v[148:151], v[28:31]
ds_read_b64 v[84:85], v212 offset:128
v_mfma_f32_16x16x32_bf16 v[32:35], v[92:95], v[152:155], v[32:35]
v_readfirstlane_b32 s24, v218
ds_read_b64_tr_b16 a[82:83], v248 offset:2048
v_mfma_f32_16x16x32_bf16 v[36:39], v[92:95], v[156:159], v[36:39]
ds_read_b64 v[86:87], v212 offset:136
v_mfma_f32_16x16x32_bf16 v[40:43], v[92:95], v[160:163], v[40:43]
ds_read_b64_tr_b16 a[84:85], v249 offset:0
v_mfma_f32_16x16x32_bf16 v[44:47], v[92:95], v[164:167], v[44:47]
s_waitcnt lgkmcnt(4)
ds_read_b64_tr_b16 a[86:87], v249 offset:2048
v_mfma_f32_16x16x32_bf16 v[48:51], v[92:95], v[168:171], v[48:51]
s_load_dword s20, s[44:45], s24
ds_read_b64_tr_b16 a[88:89], v236 offset:0
v_mfma_f32_16x16x32_bf16 v[24:27], v[88:91], v[148:151], v[24:27]
ds_read_b64_tr_b16 a[90:91], v236 offset:2048
v_mfma_f32_16x16x32_bf16 v[28:31], v[88:91], v[152:155], v[28:31]
ds_read_b64_tr_b16 a[92:93], v243 offset:0
v_mfma_f32_16x16x32_bf16 v[32:35], v[88:91], v[156:159], v[32:35]
ds_read_b128 v[176:179], v213 offset:128
v_mfma_f32_16x16x32_bf16 v[36:39], v[88:91], v[160:163], v[36:39]
ds_read_b64_tr_b16 a[94:95], v243 offset:2048
v_mfma_f32_16x16x32_bf16 v[40:43], v[88:91], v[164:167], v[40:43]
ds_read_b64 v[144:145], v212 offset:3776
v_mfma_f32_16x16x32_bf16 v[44:47], v[88:91], v[168:171], v[44:47]
ds_read_b64 v[146:147], v212 offset:3784
v_mfma_f32_16x16x32_bf16 v[48:51], v[88:91], v[172:175], v[48:51]
s_waitcnt lgkmcnt(4)
ds_read_b128 v[180:183], v213 offset:3776
v_mfma_f32_16x16x32_bf16 v[20:23], v[84:87], v[148:151], v[20:23]
ds_read_b64 v[140:141], v212 offset:3264
v_mfma_f32_16x16x32_bf16 v[24:27], v[84:87], v[152:155], v[24:27]
s_waitcnt vmcnt(9)
ds_read_b64 v[142:143], v212 offset:3272
ds_read_b128 v[184:187], v213 offset:3264
v_mfma_f32_16x16x32_bf16 v[28:31], v[84:87], v[156:159], v[28:31]
ds_read_b64 v[136:137], v212 offset:2752
ds_read_b64 v[138:139], v212 offset:2760
v_mfma_f32_16x16x32_bf16 v[32:35], v[84:87], v[160:163], v[32:35]
ds_read_b128 v[188:191], v213 offset:2752
v_mfma_f32_16x16x32_bf16 v[36:39], v[84:87], v[164:167], v[36:39]
ds_read_b64 v[132:133], v212 offset:2240
v_mfma_f32_16x16x32_bf16 v[40:43], v[84:87], v[168:171], v[40:43]
ds_read_b64 v[134:135], v212 offset:2248
v_mfma_f32_16x16x32_bf16 v[44:47], v[84:87], v[172:175], v[44:47]
s_waitcnt lgkmcnt(5)
ds_read_b128 v[192:195], v213 offset:2240
v_mfma_f32_16x16x32_bf16 v[48:51], v[84:87], v[176:179], v[48:51]
ds_read_b64 v[128:129], v212 offset:1728
v_mfma_f32_16x16x32_bf16 v[48:51], v[144:147], v[180:183], v[48:51]
ds_read_b64 v[130:131], v212 offset:1736
v_mfma_f32_16x16x32_bf16 v[44:47], v[140:143], v[180:183], v[44:47]
ds_read_b64_tr_b16 a[100:101], v248 offset:49152
v_mfma_f32_16x16x32_bf16 v[48:51], v[140:143], v[184:187], v[48:51]
s_waitcnt lgkmcnt(4)
ds_read_b64_tr_b16 a[102:103], v248 offset:51200
v_mfma_f32_16x16x32_bf16 v[40:43], v[136:139], v[180:183], v[40:43]
ds_read_b128 v[196:199], v213 offset:1728
v_mfma_f32_16x16x32_bf16 v[44:47], v[136:139], v[184:187], v[44:47]
ds_read_b64_tr_b16 a[104:105], v249 offset:49152
v_mfma_f32_16x16x32_bf16 v[48:51], v[136:139], v[188:191], v[48:51]
ds_read_b64 v[124:125], v212 offset:1216
v_mfma_f32_16x16x32_bf16 v[36:39], v[132:135], v[180:183], v[36:39]
ds_read_b64_tr_b16 a[106:107], v249 offset:51200
v_mfma_f32_16x16x32_bf16 v[40:43], v[132:135], v[184:187], v[40:43]
ds_read_b64 v[126:127], v212 offset:1224
v_mfma_f32_16x16x32_bf16 v[44:47], v[132:135], v[188:191], v[44:47]
s_waitcnt lgkmcnt(4)
ds_read_b64_tr_b16 a[108:109], v236 offset:49152
v_mfma_f32_16x16x32_bf16 v[48:51], v[132:135], v[192:195], v[48:51]
ds_read_b64_tr_b16 a[110:111], v236 offset:51200
v_mfma_f32_16x16x32_bf16 v[32:35], v[128:131], v[180:183], v[32:35]
ds_read_b64_tr_b16 a[112:113], v243 offset:49152
v_mfma_f32_16x16x32_bf16 v[36:39], v[128:131], v[184:187], v[36:39]
ds_read_b64_tr_b16 a[114:115], v243 offset:51200
v_mfma_f32_16x16x32_bf16 v[40:43], v[128:131], v[188:191], v[40:43]
ds_read_b128 v[200:203], v213 offset:1216
v_mfma_f32_16x16x32_bf16 v[44:47], v[128:131], v[192:195], v[44:47]
ds_read_b64 v[120:121], v212 offset:704
v_mfma_f32_16x16x32_bf16 v[48:51], v[128:131], v[196:199], v[48:51]
s_waitcnt lgkmcnt(0)
s_cmp_eq_u32 s20, 7
s_cbranch_scc0 LS_f21
LR_f21:
ds_read_b64 v[122:123], v212 offset:712
buffer_load_dwordx4 a[140:143], v4, s[44:47], s8 offen sc1
v_mfma_f32_16x16x32_bf16 v[28:31], v[124:127], v[180:183], v[28:31]
s_waitcnt vmcnt(2)
ds_read_b128 v[204:207], v213 offset:704
ds_read_b64 v[116:117], v212 offset:192
v_mfma_f32_16x16x32_bf16 v[32:35], v[124:127], v[184:187], v[32:35]
buffer_load_dwordx4 a[144:147], v5, s[44:47], s8 offen sc1
ds_read_b64 v[118:119], v212 offset:200
v_mfma_f32_16x16x32_bf16 v[36:39], v[124:127], v[188:191], v[36:39]
ds_read_b64_tr_b16 a[120:121], v248 offset:16384
v_mfma_f32_16x16x32_bf16 v[40:43], v[124:127], v[192:195], v[40:43]
buffer_load_dwordx4 a[148:151], v6, s[44:47], s8 offen sc1
v_mfma_f32_16x16x32_bf16 v[44:47], v[124:127], v[196:199], v[44:47]
ds_read_b64_tr_b16 a[122:123], v248 offset:18432
v_mfma_f32_16x16x32_bf16 v[48:51], v[124:127], v[200:203], v[48:51]
s_waitcnt lgkmcnt(3)
buffer_load_dwordx4 a[152:155], v7, s[44:47], s8 offen sc1
v_mfma_f32_16x16x32_bf16 v[24:27], v[120:123], v[180:183], v[24:27]
ds_read_b64_tr_b16 a[124:125], v249 offset:16384
v_mfma_f32_16x16x32_bf16 v[28:31], v[120:123], v[184:187], v[28:31]
buffer_load_dwordx4 a[156:159], v8, s[44:47], s8 offen sc1
v_mfma_f32_16x16x32_bf16 v[32:35], v[120:123], v[188:191], v[32:35]
ds_read_b128 v[208:211], v213 offset:192
v_mfma_f32_16x16x32_bf16 v[36:39], v[120:123], v[192:195], v[36:39]
buffer_load_dwordx4 a[160:163], v9, s[44:47], s8 offen sc1
v_mfma_f32_16x16x32_bf16 v[40:43], v[120:123], v[196:199], v[40:43]
ds_read_b64_tr_b16 a[126:127], v249 offset:18432
v_mfma_f32_16x16x32_bf16 v[44:47], v[120:123], v[200:203], v[44:47]
buffer_load_dwordx4 a[164:167], v10, s[44:47], s8 offen sc1
v_mfma_f32_16x16x32_bf16 v[48:51], v[120:123], v[204:207], v[48:51]
s_waitcnt lgkmcnt(2)
ds_read_b64_tr_b16 a[128:129], v236 offset:16384
v_mfma_f32_16x16x32_bf16 v[20:23], v[116:119], v[180:183], v[20:23]
buffer_load_dwordx4 a[168:171], v4, s[44:47], s9 offen sc1
v_mfma_f32_16x16x32_bf16 v[24:27], v[116:119], v[184:187], v[24:27]
ds_read_b64_tr_b16 a[130:131], v236 offset:18432
v_mfma_f32_16x16x32_bf16 v[28:31], v[116:119], v[188:191], v[28:31]
buffer_load_dwordx4 a[172:175], v5, s[44:47], s9 offen sc1
v_mfma_f32_16x16x32_bf16 v[32:35], v[116:119], v[192:195], v[32:35]
ds_read_b64_tr_b16 a[132:133], v243 offset:16384
v_mfma_f32_16x16x32_bf16 v[36:39], v[116:119], v[196:199], v[36:39]
ds_read_b64_tr_b16 a[134:135], v243 offset:18432
v_mfma_f32_16x16x32_bf16 v[40:43], v[116:119], v[200:203], v[40:43]
buffer_load_dwordx4 a[176:179], v6, s[44:47], s9 offen sc1
v_mfma_f32_16x16x32_bf16 v[44:47], v[116:119], v[204:207], v[44:47]
s_waitcnt lgkmcnt(2)
v_mfma_f32_16x16x32_bf16 v[48:51], v[116:119], v[208:211], v[48:51]
LC_end:
s_waitcnt vmcnt(9) lgkmcnt(8)
s_bitcmp1_b32 s50, 0
s_cbranch_scc1 LG_h1
v_mfma_f32_16x16x32_bf16 v[148:151], a[0:3], a[140:143], 0
buffer_load_dwordx4 a[180:183], v7, s[44:47], s9 offen sc1
v_mfma_f32_16x16x32_bf16 v[152:155], a[4:7], a[140:143], 0
s_lshl_b32 s65, s53, 3
s_lshl_b32 s66, s75, 2
v_mfma_f32_16x16x32_bf16 v[156:159], a[8:11], a[140:143], 0
s_add_u32 s65, s65, s66
s_add_u32 s67, s50, s54
v_mfma_f32_16x16x32_bf16 v[160:163], a[12:15], a[140:143], 0
ds_write_b128 v222, v[36:39] offset:0
v_mfma_f32_16x16x32_bf16 v[164:167], a[16:19], a[140:143], 0
s_waitcnt vmcnt(9)
s_and_b32 s67, s67, 3
v_and_b32 v11, 15, v1
v_mfma_f32_16x16x32_bf16 v[148:151], a[20:23], a[144:147], v[148:151]
buffer_load_dwordx4 a[184:187], v8, s[44:47], s9 offen sc1
v_mfma_f32_16x16x32_bf16 v[152:155], a[24:27], a[144:147], v[152:155]
ds_write_b128 v222, v[40:43] offset:1024
v_mfma_f32_16x16x32_bf16 v[156:159], a[28:31], a[144:147], v[156:159]
s_add_u32 s66, s65, s67
s_lshl_b32 s66, s66, 4
v_mfma_f32_16x16x32_bf16 v[160:163], a[32:35], a[144:147], v[160:163]
v_add_u32 v232, s66, v11
v_lshlrev_b32 v232, 3, v232
v_mfma_f32_16x16x32_bf16 v[164:167], a[36:39], a[144:147], v[164:167]
s_waitcnt vmcnt(9)
ds_write_b128 v222, v[44:47] offset:2048
v_mfma_f32_16x16x32_bf16 v[148:151], a[40:43], a[148:151], v[148:151]
buffer_load_dwordx4 a[188:191], v9, s[44:47], s9 offen sc1
v_mfma_f32_16x16x32_bf16 v[152:155], a[44:47], a[148:151], v[152:155]
v_add_u32 v232, 5242880, v232
v_lshrrev_b32 v12, 4, v1
v_mfma_f32_16x16x32_bf16 v[156:159], a[48:51], a[148:151], v[156:159]
ds_write_b128 v222, v[48:51] offset:3072
v_mfma_f32_16x16x32_bf16 v[160:163], a[52:55], a[148:151], v[160:163]
v_mul_u32_u24 v13, 160, v11
v_lshl_add_u32 v13, v12, 3, v13
v_mfma_f32_16x16x32_bf16 v[164:167], a[56:59], a[148:151], v[164:167]
s_waitcnt vmcnt(9)
s_mul_i32 s17, s50, 3072
s_add_u32 s17, s17, 136192
v_mfma_f32_16x16x32_bf16 v[148:151], a[60:63], a[152:155], v[148:151]
buffer_load_dwordx4 a[192:195], v10, s[44:47], s9 offen sc1
v_mfma_f32_16x16x32_bf16 v[152:155], a[64:67], a[152:155], v[152:155]
v_add_u32 v231, s17, v13
s_mul_i32 s3, s66, 1280
v_mfma_f32_16x16x32_bf16 v[156:159], a[68:71], a[152:155], v[156:159]
s_lshl_b32 s62, s54, 7
s_add_u32 s3, s3, s62
v_mfma_f32_16x16x32_bf16 v[160:163], a[72:75], a[152:155], v[160:163]
s_waitcnt lgkmcnt(0)
s_barrier
buffer_atomic_add v3, v234, s[44:47], 0 offen sc1
ds_read_b128 v[52:55], v223 offset:0
s_mul_i32 s62, s54, 96
v_mfma_f32_16x16x32_bf16 v[164:167], a[76:79], a[152:155], v[164:167]
s_waitcnt vmcnt(10)
ds_read_b128 v[56:59], v223 offset:1024
s_sub_u32 s64, 896, s62
v_mfma_f32_16x16x32_bf16 v[148:151], a[80:83], a[156:159], v[148:151]
buffer_load_dwordx4 a[196:199], v4, s[44:47], s10 offen sc1
v_mfma_f32_16x16x32_bf16 v[152:155], a[84:87], a[156:159], v[152:155]
ds_read_b128 v[60:63], v223 offset:2048
v_add_u32 v11, 0, v1
v_mfma_f32_16x16x32_bf16 v[156:159], a[88:91], a[156:159], v[156:159]
ds_read_b128 v[64:67], v223 offset:3072
v_mul_u32_u24 v13, 6554, v11
v_mfma_f32_16x16x32_bf16 v[160:163], a[92:95], a[156:159], v[160:163]
v_lshrrev_b32 v13, 16, v13
v_mul_u32_u24 v224, 1120, v13
v_mfma_f32_16x16x32_bf16 v[164:167], a[96:99], a[156:159], v[164:167]
s_waitcnt vmcnt(10)
v_lshl_add_u32 v224, v11, 4, v224
v_mul_u32_u24 v13, 10, v13
v_mfma_f32_16x16x32_bf16 v[148:151], a[100:103], a[160:163], v[148:151]
buffer_load_dwordx4 a[200:203], v5, s[44:47], s10 offen sc1
v_mfma_f32_16x16x32_bf16 v[152:155], a[104:107], a[160:163], v[152:155]
v_sub_u32 v11, v11, v13
v_lshrrev_b32 v11, 3, v11
v_mfma_f32_16x16x32_bf16 v[156:159], a[108:111], a[160:163], v[156:159]
s_waitcnt lgkmcnt(0)
v_add_f32 v20, v20, v52
v_add_f32 v21, v21, v53
v_mfma_f32_16x16x32_bf16 v[160:163], a[112:115], a[160:163], v[160:163]
v_add_f32 v22, v22, v54
v_add_f32 v23, v23, v55
v_mfma_f32_16x16x32_bf16 v[164:167], a[116:119], a[160:163], v[164:167]
s_waitcnt vmcnt(10)
v_add_f32 v24, v24, v56
v_add_f32 v25, v25, v57
v_mfma_f32_16x16x32_bf16 v[148:151], a[120:123], a[164:167], v[148:151]
buffer_load_dwordx4 a[204:207], v6, s[44:47], s10 offen sc1
v_mfma_f32_16x16x32_bf16 v[152:155], a[124:127], a[164:167], v[152:155]
v_add_f32 v26, v26, v58
v_add_f32 v27, v27, v59
v_mfma_f32_16x16x32_bf16 v[156:159], a[128:131], a[164:167], v[156:159]
v_cvt_pk_bf16_f32 v68, v20, v21
v_cvt_pk_bf16_f32 v69, v22, v23
v_mfma_f32_16x16x32_bf16 v[160:163], a[132:135], a[164:167], v[160:163]
v_cvt_pk_bf16_f32 v70, v24, v25
v_cvt_pk_bf16_f32 v71, v26, v27
v_mfma_f32_16x16x32_bf16 v[164:167], a[136:139], a[164:167], v[164:167]
s_waitcnt vmcnt(10)
v_add_f32 v28, v28, v60
v_add_f32 v29, v29, v61
v_mfma_f32_16x16x32_bf16 v[168:171], a[0:3], a[168:171], 0
buffer_load_dwordx4 a[208:211], v7, s[44:47], s10 offen sc1
v_mfma_f32_16x16x32_bf16 v[172:175], a[4:7], a[168:171], 0
v_add_f32 v30, v30, v62
v_add_f32 v31, v31, v63
v_mfma_f32_16x16x32_bf16 v[176:179], a[8:11], a[168:171], 0
v_add_f32 v32, v32, v64
v_add_f32 v33, v33, v65
v_mfma_f32_16x16x32_bf16 v[180:183], a[12:15], a[168:171], 0
v_add_f32 v34, v34, v66
v_add_f32 v35, v35, v67
v_mfma_f32_16x16x32_bf16 v[184:187], a[16:19], a[168:171], 0
s_waitcnt vmcnt(10)
v_cvt_pk_bf16_f32 v72, v28, v29
v_cvt_pk_bf16_f32 v73, v30, v31
v_mfma_f32_16x16x32_bf16 v[168:171], a[20:23], a[172:175], v[168:171]
buffer_load_dwordx4 a[212:215], v8, s[44:47], s10 offen sc1
v_cvt_pk_bf16_f32 v74, v32, v33
v_mfma_f32_16x16x32_bf16 v[172:175], a[24:27], a[172:175], v[172:175]
v_cvt_pk_bf16_f32 v75, v34, v35
s_nop 0
v_mfma_f32_16x16x32_bf16 v[176:179], a[28:31], a[172:175], v[176:179]
v_permlane16_swap_b32 v68, v70
v_permlane16_swap_b32 v69, v71
v_mfma_f32_16x16x32_bf16 v[180:183], a[32:35], a[172:175], v[180:183]
v_permlane16_swap_b32 v72, v74
v_permlane16_swap_b32 v73, v75
v_mfma_f32_16x16x32_bf16 v[184:187], a[36:39], a[172:175], v[184:187]
s_waitcnt vmcnt(10)
buffer_store_dwordx4 v[68:71], v217, s[44:47], s69 offen offset:0 sc1
v_mfma_f32_16x16x32_bf16 v[168:171], a[40:43], a[176:179], v[168:171]
buffer_load_dwordx4 a[216:219], v9, s[44:47], s10 offen sc1
v_mfma_f32_16x16x32_bf16 v[172:175], a[44:47], a[176:179], v[172:175]
buffer_store_dwordx4 v[72:75], v217, s[44:47], s69 offen offset:1024 sc1
v_mfma_f32_16x16x32_bf16 v[176:179], a[48:51], a[176:179], v[176:179]
buffer_store_dwordx2 v[16:17], v221, s[44:47], 0 offen sc1
v_mfma_f32_16x16x32_bf16 v[180:183], a[52:55], a[176:179], v[180:183]
v_add_u32 v117, s13, v18
v_mul_u32_u24 v11, s64, v11
v_mfma_f32_16x16x32_bf16 v[184:187], a[56:59], a[176:179], v[184:187]
s_waitcnt vmcnt(13)
s_barrier
v_add3_u32 v224, v224, v11, s3
v_add_u32 v11, 64, v1
s_branch LG_j
LG_h1:
v_mfma_f32_16x16x32_bf16 v[148:151], a[0:3], a[140:143], 0
buffer_load_dwordx4 a[180:183], v7, s[44:47], s9 offen sc1
v_mfma_f32_16x16x32_bf16 v[152:155], a[4:7], a[140:143], 0
s_lshl_b32 s65, s53, 3
s_lshl_b32 s66, s75, 2
v_mfma_f32_16x16x32_bf16 v[156:159], a[8:11], a[140:143], 0
s_add_u32 s65, s65, s66
s_add_u32 s67, s50, s54
v_mfma_f32_16x16x32_bf16 v[160:163], a[12:15], a[140:143], 0
ds_write_b128 v222, v[20:23] offset:0
v_mfma_f32_16x16x32_bf16 v[164:167], a[16:19], a[140:143], 0
s_waitcnt vmcnt(9)
s_and_b32 s67, s67, 3
v_and_b32 v11, 15, v1
v_mfma_f32_16x16x32_bf16 v[148:151], a[20:23], a[144:147], v[148:151]
buffer_load_dwordx4 a[184:187], v8, s[44:47], s9 offen sc1
v_mfma_f32_16x16x32_bf16 v[152:155], a[24:27], a[144:147], v[152:155]
ds_write_b128 v222, v[24:27] offset:1024
v_mfma_f32_16x16x32_bf16 v[156:159], a[28:31], a[144:147], v[156:159]
s_add_u32 s66, s65, s67
s_lshl_b32 s66, s66, 4
v_mfma_f32_16x16x32_bf16 v[160:163], a[32:35], a[144:147], v[160:163]
v_add_u32 v232, s66, v11
v_lshlrev_b32 v232, 3, v232
v_mfma_f32_16x16x32_bf16 v[164:167], a[36:39], a[144:147], v[164:167]
s_waitcnt vmcnt(9)
ds_write_b128 v222, v[28:31] offset:2048
v_mfma_f32_16x16x32_bf16 v[148:151], a[40:43], a[148:151], v[148:151]
buffer_load_dwordx4 a[188:191], v9, s[44:47], s9 offen sc1
v_mfma_f32_16x16x32_bf16 v[152:155], a[44:47], a[148:151], v[152:155]
v_add_u32 v232, 5242880, v232
v_lshrrev_b32 v12, 4, v1
v_mfma_f32_16x16x32_bf16 v[156:159], a[48:51], a[148:151], v[156:159]
ds_write_b128 v222, v[32:35] offset:3072
v_mfma_f32_16x16x32_bf16 v[160:163], a[52:55], a[148:151], v[160:163]
v_mul_u32_u24 v13, 160, v11
v_lshl_add_u32 v13, v12, 3, v13
v_mfma_f32_16x16x32_bf16 v[164:167], a[56:59], a[148:151], v[164:167]
s_waitcnt vmcnt(9)
s_mul_i32 s17, s50, 3072
s_add_u32 s17, s17, 136192
v_mfma_f32_16x16x32_bf16 v[148:151], a[60:63], a[152:155], v[148:151]
buffer_load_dwordx4 a[192:195], v10, s[44:47], s9 offen sc1
v_mfma_f32_16x16x32_bf16 v[152:155], a[64:67], a[152:155], v[152:155]
v_add_u32 v231, s17, v13
s_mul_i32 s3, s66, 1280
v_mfma_f32_16x16x32_bf16 v[156:159], a[68:71], a[152:155], v[156:159]
s_lshl_b32 s62, s54, 7
s_add_u32 s3, s3, s62
v_mfma_f32_16x16x32_bf16 v[160:163], a[72:75], a[152:155], v[160:163]
s_waitcnt lgkmcnt(0)
s_barrier
buffer_atomic_add v3, v234, s[44:47], 0 offen sc1
ds_read_b128 v[52:55], v223 offset:0
s_mul_i32 s62, s54, 96
v_mfma_f32_16x16x32_bf16 v[164:167], a[76:79], a[152:155], v[164:167]
s_waitcnt vmcnt(10)
ds_read_b128 v[56:59], v223 offset:1024
s_sub_u32 s64, 896, s62
v_mfma_f32_16x16x32_bf16 v[148:151], a[80:83], a[156:159], v[148:151]
buffer_load_dwordx4 a[196:199], v4, s[44:47], s10 offen sc1
v_mfma_f32_16x16x32_bf16 v[152:155], a[84:87], a[156:159], v[152:155]
ds_read_b128 v[60:63], v223 offset:2048
v_add_u32 v11, 0, v1
v_mfma_f32_16x16x32_bf16 v[156:159], a[88:91], a[156:159], v[156:159]
ds_read_b128 v[64:67], v223 offset:3072
v_mul_u32_u24 v13, 6554, v11
v_mfma_f32_16x16x32_bf16 v[160:163], a[92:95], a[156:159], v[160:163]
v_lshrrev_b32 v13, 16, v13
v_mul_u32_u24 v224, 1120, v13
v_mfma_f32_16x16x32_bf16 v[164:167], a[96:99], a[156:159], v[164:167]
s_waitcnt vmcnt(10)
v_lshl_add_u32 v224, v11, 4, v224
v_mul_u32_u24 v13, 10, v13
v_mfma_f32_16x16x32_bf16 v[148:151], a[100:103], a[160:163], v[148:151]
buffer_load_dwordx4 a[200:203], v5, s[44:47], s10 offen sc1
v_mfma_f32_16x16x32_bf16 v[152:155], a[104:107], a[160:163], v[152:155]
v_sub_u32 v11, v11, v13
v_lshrrev_b32 v11, 3, v11
v_mfma_f32_16x16x32_bf16 v[156:159], a[108:111], a[160:163], v[156:159]
s_waitcnt lgkmcnt(0)
v_add_f32 v36, v36, v52
v_add_f32 v37, v37, v53
v_mfma_f32_16x16x32_bf16 v[160:163], a[112:115], a[160:163], v[160:163]
v_add_f32 v38, v38, v54
v_add_f32 v39, v39, v55
v_mfma_f32_16x16x32_bf16 v[164:167], a[116:119], a[160:163], v[164:167]
s_waitcnt vmcnt(10)
v_add_f32 v40, v40, v56
v_add_f32 v41, v41, v57
v_mfma_f32_16x16x32_bf16 v[148:151], a[120:123], a[164:167], v[148:151]
buffer_load_dwordx4 a[204:207], v6, s[44:47], s10 offen sc1
v_mfma_f32_16x16x32_bf16 v[152:155], a[124:127], a[164:167], v[152:155]
v_add_f32 v42, v42, v58
v_add_f32 v43, v43, v59
v_mfma_f32_16x16x32_bf16 v[156:159], a[128:131], a[164:167], v[156:159]
v_cvt_pk_bf16_f32 v68, v36, v37
v_cvt_pk_bf16_f32 v69, v38, v39
v_mfma_f32_16x16x32_bf16 v[160:163], a[132:135], a[164:167], v[160:163]
v_cvt_pk_bf16_f32 v70, v40, v41
v_cvt_pk_bf16_f32 v71, v42, v43
v_mfma_f32_16x16x32_bf16 v[164:167], a[136:139], a[164:167], v[164:167]
s_waitcnt vmcnt(10)
v_add_f32 v44, v44, v60
v_add_f32 v45, v45, v61
v_mfma_f32_16x16x32_bf16 v[168:171], a[0:3], a[168:171], 0
buffer_load_dwordx4 a[208:211], v7, s[44:47], s10 offen sc1
v_mfma_f32_16x16x32_bf16 v[172:175], a[4:7], a[168:171], 0
v_add_f32 v46, v46, v62
v_add_f32 v47, v47, v63
v_mfma_f32_16x16x32_bf16 v[176:179], a[8:11], a[168:171], 0
v_add_f32 v48, v48, v64
v_add_f32 v49, v49, v65
v_mfma_f32_16x16x32_bf16 v[180:183], a[12:15], a[168:171], 0
v_add_f32 v50, v50, v66
v_add_f32 v51, v51, v67
v_mfma_f32_16x16x32_bf16 v[184:187], a[16:19], a[168:171], 0
s_waitcnt vmcnt(10)
v_cvt_pk_bf16_f32 v72, v44, v45
v_cvt_pk_bf16_f32 v73, v46, v47
v_mfma_f32_16x16x32_bf16 v[168:171], a[20:23], a[172:175], v[168:171]
buffer_load_dwordx4 a[212:215], v8, s[44:47], s10 offen sc1
v_cvt_pk_bf16_f32 v74, v48, v49
v_mfma_f32_16x16x32_bf16 v[172:175], a[24:27], a[172:175], v[172:175]
v_cvt_pk_bf16_f32 v75, v50, v51
s_nop 0
v_mfma_f32_16x16x32_bf16 v[176:179], a[28:31], a[172:175], v[176:179]
v_permlane16_swap_b32 v68, v70
v_permlane16_swap_b32 v69, v71
v_mfma_f32_16x16x32_bf16 v[180:183], a[32:35], a[172:175], v[180:183]
v_permlane16_swap_b32 v72, v74
v_permlane16_swap_b32 v73, v75
v_mfma_f32_16x16x32_bf16 v[184:187], a[36:39], a[172:175], v[184:187]
s_waitcnt vmcnt(10)
buffer_store_dwordx4 v[68:71], v217, s[44:47], s69 offen offset:2048 sc1
v_mfma_f32_16x16x32_bf16 v[168:171], a[40:43], a[176:179], v[168:171]
buffer_load_dwordx4 a[216:219], v9, s[44:47], s10 offen sc1
v_mfma_f32_16x16x32_bf16 v[172:175], a[44:47], a[176:179], v[172:175]
buffer_store_dwordx4 v[72:75], v217, s[44:47], s69 offen offset:3072 sc1
v_mfma_f32_16x16x32_bf16 v[176:179], a[48:51], a[176:179], v[176:179]
buffer_store_dwordx2 v[16:17], v221, s[44:47], 0 offen sc1
v_mfma_f32_16x16x32_bf16 v[180:183], a[52:55], a[176:179], v[180:183]
v_add_u32 v117, s13, v18
v_mul_u32_u24 v11, s64, v11
v_mfma_f32_16x16x32_bf16 v[184:187], a[56:59], a[176:179], v[184:187]
s_waitcnt vmcnt(13)
s_barrier
v_add3_u32 v224, v224, v11, s3
v_add_u32 v11, 64, v1
LG_j:
v_mfma_f32_16x16x32_bf16 v[168:171], a[60:63], a[180:183], v[168:171]
buffer_load_dwordx4 a[220:223], v10, s[44:47], s10 offen sc1
v_mfma_f32_16x16x32_bf16 v[172:175], a[64:67], a[180:183], v[172:175]
v_mul_u32_u24 v13, 6554, v11
v_lshrrev_b32 v13, 16, v13
v_mfma_f32_16x16x32_bf16 v[176:179], a[68:71], a[180:183], v[176:179]
ds_write_b128 v117, v[148:151] offset:0
v_mfma_f32_16x16x32_bf16 v[180:183], a[72:75], a[180:183], v[180:183]
v_mul_u32_u24 v225, 1120, v13
v_lshl_add_u32 v225, v11, 4, v225
v_mfma_f32_16x16x32_bf16 v[184:187], a[76:79], a[180:183], v[184:187]
s_waitcnt vmcnt(13)
v_readfirstlane_b32 s26, v237
v_mul_u32_u24 v13, 10, v13
v_sub_u32 v11, v11, v13
v_mfma_f32_16x16x32_bf16 v[168:171], a[80:83], a[184:187], v[168:171]
buffer_load_dwordx4 a[224:227], v4, s[44:47], s11 offen sc1
v_mfma_f32_16x16x32_bf16 v[172:175], a[84:87], a[184:187], v[172:175]
ds_write_b128 v117, v[152:155] offset:1024
v_mfma_f32_16x16x32_bf16 v[176:179], a[88:91], a[184:187], v[176:179]
v_lshrrev_b32 v11, 3, v11
v_mul_u32_u24 v11, s64, v11
v_mfma_f32_16x16x32_bf16 v[180:183], a[92:95], a[184:187], v[180:183]
v_add3_u32 v225, v225, v11, s3
v_add_u32 v11, 128, v1
v_mfma_f32_16x16x32_bf16 v[184:187], a[96:99], a[184:187], v[184:187]
s_waitcnt vmcnt(13)
v_mul_u32_u24 v13, 6554, v11
v_lshrrev_b32 v13, 16, v13
v_mfma_f32_16x16x32_bf16 v[168:171], a[100:103], a[188:191], v[168:171]
buffer_load_dwordx4 a[228:231], v5, s[44:47], s11 offen sc1
v_mfma_f32_16x16x32_bf16 v[172:175], a[104:107], a[188:191], v[172:175]
ds_write_b128 v117, v[156:159] offset:2048
v_mfma_f32_16x16x32_bf16 v[176:179], a[108:111], a[188:191], v[176:179]
buffer_load_dwordx2 v[114:115], v232, s[44:47], 0 offen sc1
v_mfma_f32_16x16x32_bf16 v[180:183], a[112:115], a[188:191], v[180:183]
s_mov_b32 s63, 131072
s_mov_b32 s68, 0
v_mfma_f32_16x16x32_bf16 v[184:187], a[116:119], a[188:191], v[184:187]
s_waitcnt vmcnt(14)
ds_write_b128 v117, v[160:163] offset:3072
v_mfma_f32_16x16x32_bf16 v[168:171], a[120:123], a[192:195], v[168:171]
buffer_load_dwordx4 a[232:235], v6, s[44:47], s11 offen sc1
v_mfma_f32_16x16x32_bf16 v[172:175], a[124:127], a[192:195], v[172:175]
v_mul_u32_u24 v226, 1120, v13
v_lshl_add_u32 v226, v11, 4, v226
v_mfma_f32_16x16x32_bf16 v[176:179], a[128:131], a[192:195], v[176:179]
v_mul_u32_u24 v13, 10, v13
v_sub_u32 v11, v11, v13
v_mfma_f32_16x16x32_bf16 v[180:183], a[132:135], a[192:195], v[180:183]
ds_write_b128 v117, v[164:167] offset:4096
v_mfma_f32_16x16x32_bf16 v[184:187], a[136:139], a[192:195], v[184:187]
s_waitcnt vmcnt(13)
v_lshrrev_b32 v11, 3, v11
v_mul_u32_u24 v11, s64, v11
v_mfma_f32_16x16x32_bf16 v[188:191], a[0:3], a[196:199], 0
buffer_load_dwordx4 a[236:239], v7, s[44:47], s11 offen sc1
v_mfma_f32_16x16x32_bf16 v[192:195], a[4:7], a[196:199], 0
v_add3_u32 v226, v226, v11, s3
v_and_b32 v11, 32, v1
v_mfma_f32_16x16x32_bf16 v[196:199], a[8:11], a[196:199], 0
v_add_u32 v117, s14, v18
v_lshl_or_b32 v226, v11, 26, v226
v_mfma_f32_16x16x32_bf16 v[200:203], a[12:15], a[196:199], 0
s_mul_i32 s62, s67, 15360
v_add_u32 v233, s62, v18
v_mfma_f32_16x16x32_bf16 v[204:207], a[16:19], a[196:199], 0
s_waitcnt vmcnt(13)
v_and_b32 v11, 15, v1
v_mul_u32_u24 v11, 1280, v11
v_mfma_f32_16x16x32_bf16 v[188:191], a[20:23], a[200:203], v[188:191]
buffer_load_dwordx4 a[240:243], v8, s[44:47], s11 offen sc1
v_mfma_f32_16x16x32_bf16 v[192:195], a[24:27], a[200:203], v[192:195]
v_lshlrev_b32 v13, 3, v12
v_add3_u32 v230, v11, v13, s3
v_mfma_f32_16x16x32_bf16 v[196:199], a[28:31], a[200:203], v[196:199]
ds_write_b128 v117, v[168:171] offset:0
v_mfma_f32_16x16x32_bf16 v[200:203], a[32:35], a[200:203], v[200:203]
v_and_b32 v13, 1, v12
v_mul_u32_u24 v13, 24, v13
v_mfma_f32_16x16x32_bf16 v[204:207], a[36:39], a[200:203], v[204:207]
s_waitcnt vmcnt(13)
v_add_u32 v228, v230, v13
v_add_u32 v230, s64, v230
v_mfma_f32_16x16x32_bf16 v[188:191], a[40:43], a[204:207], v[188:191]
buffer_load_dwordx4 a[244:247], v9, s[44:47], s11 offen sc1
v_mfma_f32_16x16x32_bf16 v[192:195], a[44:47], a[204:207], v[192:195]
ds_write_b128 v117, v[172:175] offset:1024
v_mfma_f32_16x16x32_bf16 v[196:199], a[48:51], a[204:207], v[196:199]
s_add_u32 m0, s17, 0
s_nop 0
v_mfma_f32_16x16x32_bf16 v[200:203], a[52:55], a[204:207], v[200:203]
buffer_load_dwordx4 v224, s[4:7], 0 offen lds
v_mfma_f32_16x16x32_bf16 v[204:207], a[56:59], a[204:207], v[204:207]
s_waitcnt vmcnt(14)
v_bfe_u32 v11, v1, 3, 2
v_xor_b32 v11, s67, v11
v_mfma_f32_16x16x32_bf16 v[188:191], a[60:63], a[208:211], v[188:191]
buffer_load_dwordx4 a[248:251], v10, s[44:47], s11 offen sc1
v_mfma_f32_16x16x32_bf16 v[192:195], a[64:67], a[208:211], v[192:195]
ds_write_b128 v117, v[176:179] offset:2048
v_mfma_f32_16x16x32_bf16 v[196:199], a[68:71], a[208:211], v[196:199]
s_add_u32 m0, s17, 1024
s_nop 0
v_mfma_f32_16x16x32_bf16 v[200:203], a[72:75], a[208:211], v[200:203]
buffer_load_dwordx4 v225, s[4:7], 0 offen lds
v_mfma_f32_16x16x32_bf16 v[204:207], a[76:79], a[208:211], v[204:207]
s_waitcnt vmcnt(15)
ds_write_b128 v117, v[180:183] offset:3072
v_mfma_f32_16x16x32_bf16 v[188:191], a[80:83], a[212:215], v[188:191]
s_add_u32 s8, s8, s12
s_add_u32 m0, s17, 2048
v_mfma_f32_16x16x32_bf16 v[192:195], a[84:87], a[212:215], v[192:195]
s_nop 0
buffer_load_dwordx4 a[140:143], v4, s[44:47], s8 offen sc1
v_mfma_f32_16x16x32_bf16 v[196:199], a[88:91], a[212:215], v[196:199]
buffer_load_dwordx4 v226, s[4:7], 0 offen lds
v_mfma_f32_16x16x32_bf16 v[200:203], a[92:95], a[212:215], v[200:203]
ds_write_b128 v117, v[184:187] offset:4096
v_mfma_f32_16x16x32_bf16 v[204:207], a[96:99], a[212:215], v[204:207]
s_waitcnt vmcnt(15)
v_lshlrev_b32 v11, 5, v11
v_lshrrev_b32 v12, 2, v1
v_mfma_f32_16x16x32_bf16 v[188:191], a[100:103], a[216:219], v[188:191]
buffer_load_dwordx4 a[144:147], v5, s[44:47], s8 offen sc1
v_mfma_f32_16x16x32_bf16 v[192:195], a[104:107], a[216:219], v[192:195]
v_lshl_add_u32 v11, v12, 7, v11
v_and_b32 v12, 3, v1
v_mfma_f32_16x16x32_bf16 v[196:199], a[108:111], a[216:219], v[196:199]
v_lshl_add_u32 v11, v12, 3, v11
v_add_u32 v229, 122880, v11
v_mfma_f32_16x16x32_bf16 v[200:203], a[112:115], a[216:219], v[200:203]
s_mul_i32 s3, s54, 13120
s_lshr_b32 s62, s3, 14
v_mfma_f32_16x16x32_bf16 v[204:207], a[116:119], a[216:219], v[204:207]
s_waitcnt vmcnt(13) lgkmcnt(0)
s_barrier
ds_read_b128 v[20:23], v233 offset:0
s_lshl_b32 s62, s62, 7
v_mfma_f32_16x16x32_bf16 v[188:191], a[120:123], a[220:223], v[188:191]
buffer_load_dwordx4 a[148:151], v6, s[44:47], s8 offen sc1
v_mfma_f32_16x16x32_bf16 v[192:195], a[124:127], a[220:223], v[192:195]
ds_read_b128 v[24:27], v233 offset:1024
s_add_u32 s28, s62, 5279744
v_mfma_f32_16x16x32_bf16 v[196:199], a[128:131], a[220:223], v[196:199]
ds_read_b128 v[28:31], v233 offset:2048
s_add_u32 s3, s3, 12915
v_mfma_f32_16x16x32_bf16 v[200:203], a[132:135], a[220:223], v[200:203]
ds_read_b128 v[32:35], v233 offset:3072
s_lshr_b32 s62, s3, 14
v_mfma_f32_16x16x32_bf16 v[204:207], a[136:139], a[220:223], v[204:207]
s_waitcnt vmcnt(13)
ds_read_b128 v[36:39], v233 offset:4096
s_lshl_b32 s62, s62, 7
v_mfma_f32_16x16x32_bf16 v[84:87], a[0:3], a[224:227], 0
buffer_load_dwordx4 a[152:155], v7, s[44:47], s8 offen sc1
v_mfma_f32_16x16x32_bf16 v[88:91], a[4:7], a[224:227], 0
ds_read_b128 v[40:43], v233 offset:5120
s_add_u32 s29, s62, 5279744
v_mfma_f32_16x16x32_bf16 v[92:95], a[8:11], a[224:227], 0
ds_read_b128 v[44:47], v233 offset:6144
v_add_u32 v117, s15, v18
v_mfma_f32_16x16x32_bf16 v[96:99], a[12:15], a[224:227], 0
ds_read_b128 v[48:51], v233 offset:7168
s_add_u32 s3, s54, 5
v_mfma_f32_16x16x32_bf16 v[100:103], a[16:19], a[224:227], 0
s_waitcnt vmcnt(13)
ds_read_b128 v[52:55], v233 offset:8192
s_lshr_b32 s3, s3, 3
v_mfma_f32_16x16x32_bf16 v[84:87], a[20:23], a[228:231], v[84:87]
buffer_load_dwordx4 a[156:159], v8, s[44:47], s8 offen sc1
v_mfma_f32_16x16x32_bf16 v[88:91], a[24:27], a[228:231], v[88:91]
ds_read_b128 v[56:59], v233 offset:9216
s_lshl_b32 s3, s3, 7
v_mfma_f32_16x16x32_bf16 v[92:95], a[28:31], a[228:231], v[92:95]
ds_write_b128 v117, v[188:191] offset:0
v_mfma_f32_16x16x32_bf16 v[96:99], a[32:35], a[228:231], v[96:99]
s_add_u32 s30, s3, 5280512
v_lshrrev_b32 v11, 3, v0
v_mfma_f32_16x16x32_bf16 v[100:103], a[36:39], a[228:231], v[100:103]
s_waitcnt vmcnt(12)
v_and_b32 v12, 7, v0
v_and_b32 v13, 6, v11
v_mfma_f32_16x16x32_bf16 v[84:87], a[40:43], a[232:235], v[84:87]
buffer_load_dwordx4 a[160:163], v9, s[44:47], s8 offen sc1
v_mfma_f32_16x16x32_bf16 v[88:91], a[44:47], a[232:235], v[88:91]
s_waitcnt lgkmcnt(1)
ds_write_b128 v117, v[192:195] offset:1024
v_mfma_f32_16x16x32_bf16 v[92:95], a[48:51], a[232:235], v[92:95]
v_xor_b32 v12, v12, v13
v_lshlrev_b32 v12, 4, v12
v_mfma_f32_16x16x32_bf16 v[96:99], a[52:55], a[232:235], v[96:99]
ds_write_b128 v117, v[196:199] offset:2048
v_mfma_f32_16x16x32_bf16 v[100:103], a[56:59], a[232:235], v[100:103]
s_waitcnt vmcnt(12)
v_lshl_add_u32 v227, v11, 12, v12
s_lshl_b32 s3, s54, 18
v_mfma_f32_16x16x32_bf16 v[84:87], a[60:63], a[236:239], v[84:87]
buffer_load_dwordx4 a[164:167], v10, s[44:47], s8 offen sc1
v_mfma_f32_16x16x32_bf16 v[88:91], a[64:67], a[236:239], v[88:91]
ds_write_b128 v117, v[200:203] offset:3072
v_mfma_f32_16x16x32_bf16 v[92:95], a[68:71], a[236:239], v[92:95]
s_lshl_b32 s62, s65, 5
s_add_u32 s3, s3, s62
v_mfma_f32_16x16x32_bf16 v[96:99], a[72:75], a[236:239], v[96:99]
s_add_u32 s3, s3, 2621440
v_add_u32 v227, s3, v227
v_mfma_f32_16x16x32_bf16 v[100:103], a[76:79], a[236:239], v[100:103]
s_waitcnt vmcnt(12)
ds_write_b128 v117, v[204:207] offset:4096
v_mfma_f32_16x16x32_bf16 v[84:87], a[80:83], a[240:243], v[84:87]
s_add_u32 s9, s9, s12
s_and_b32 s3, s50, 2
v_mfma_f32_16x16x32_bf16 v[88:91], a[84:87], a[240:243], v[88:91]
buffer_load_dwordx4 a[168:171], v4, s[44:47], s9 offen sc1
v_mfma_f32_16x16x32_bf16 v[92:95], a[88:91], a[240:243], v[92:95]
s_lshl_b32 s3, s3, 4
s_sub_u32 s16, 64, s3
v_mfma_f32_16x16x32_bf16 v[96:99], a[92:95], a[240:243], v[96:99]
s_lshl_b32 s64, s50, 10
s_add_u32 s64, s64, 122880
v_mfma_f32_16x16x32_bf16 v[100:103], a[96:99], a[240:243], v[100:103]
s_waitcnt vmcnt(12) lgkmcnt(0)
s_barrier
ds_read_b128 v[60:63], v233 offset:10240
s_lshl_b32 s65, s16, 7
v_mfma_f32_16x16x32_bf16 v[84:87], a[100:103], a[244:247], v[84:87]
buffer_load_dwordx4 a[172:175], v5, s[44:47], s9 offen sc1
v_mfma_f32_16x16x32_bf16 v[88:91], a[104:107], a[244:247], v[88:91]
ds_read_b128 v[64:67], v233 offset:11264
s_add_u32 s65, s65, s64
v_mfma_f32_16x16x32_bf16 v[92:95], a[108:111], a[244:247], v[92:95]
ds_read_b128 v[68:71], v233 offset:12288
s_mul_i32 s3, s54, 48
v_mfma_f32_16x16x32_bf16 v[96:99], a[112:115], a[244:247], v[96:99]
ds_read_b128 v[72:75], v233 offset:13312
s_sub_u32 s3, 512, s3
v_mfma_f32_16x16x32_bf16 v[100:103], a[116:119], a[244:247], v[100:103]
s_waitcnt vmcnt(11)
ds_read_b128 v[76:79], v233 offset:14336
s_lshl_b32 s31, s3, 12
v_mfma_f32_16x16x32_bf16 v[84:87], a[120:123], a[248:251], v[84:87]
buffer_load_dwordx4 a[176:179], v6, s[44:47], s9 offen sc1
v_mfma_f32_16x16x32_bf16 v[88:91], a[124:127], a[248:251], v[88:91]
s_cmp_ge_u32 s50, 2
s_cselect_b32 s16, 131072, s31
v_mfma_f32_16x16x32_bf16 v[92:95], a[128:131], a[248:251], v[92:95]
v_add_f32 v20, v20, v40
v_add_f32 v21, v21, v41
v_mfma_f32_16x16x32_bf16 v[96:99], a[132:135], a[248:251], v[96:99]
v_add_f32 v22, v22, v42
v_add_f32 v23, v23, v43
v_mfma_f32_16x16x32_bf16 v[100:103], a[136:139], a[248:251], v[100:103]
s_waitcnt vmcnt(10)
v_add_f32 v24, v24, v44
v_add_f32 v25, v25, v45
v_mfma_f32_16x16x32_bf16 v[148:151], a[0:3], a[140:143], 0
buffer_load_dwordx4 a[180:183], v7, s[44:47], s9 offen sc1
v_mfma_f32_16x16x32_bf16 v[152:155], a[4:7], a[140:143], 0
v_add_f32 v26, v26, v46
v_add_f32 v27, v27, v47
v_mfma_f32_16x16x32_bf16 v[156:159], a[8:11], a[140:143], 0
v_add_f32 v28, v28, v48
v_add_f32 v29, v29, v49
v_mfma_f32_16x16x32_bf16 v[160:163], a[12:15], a[140:143], 0
v_add_f32 v30, v30, v50
v_add_f32 v31, v31, v51
v_mfma_f32_16x16x32_bf16 v[164:167], a[16:19], a[140:143], 0
s_waitcnt vmcnt(9)
v_add_f32 v32, v32, v52
v_add_f32 v33, v33, v53
v_mfma_f32_16x16x32_bf16 v[148:151], a[20:23], a[144:147], v[148:151]
buffer_load_dwordx4 a[184:187], v8, s[44:47], s9 offen sc1
v_mfma_f32_16x16x32_bf16 v[152:155], a[24:27], a[144:147], v[152:155]
v_add_f32 v34, v34, v54
v_add_f32 v35, v35, v55
v_mfma_f32_16x16x32_bf16 v[156:159], a[28:31], a[144:147], v[156:159]
v_add_f32 v36, v36, v56
v_add_f32 v37, v37, v57
v_mfma_f32_16x16x32_bf16 v[160:163], a[32:35], a[144:147], v[160:163]
v_add_f32 v38, v38, v58
v_add_f32 v39, v39, v59
v_mfma_f32_16x16x32_bf16 v[164:167], a[36:39], a[144:147], v[164:167]
s_waitcnt vmcnt(9)
s_waitcnt lgkmcnt(0)
v_add_f32 v20, v20, v60
v_mfma_f32_16x16x32_bf16 v[148:151], a[40:43], a[148:151], v[148:151]
buffer_load_dwordx4 a[188:191], v9, s[44:47], s9 offen sc1
v_mfma_f32_16x16x32_bf16 v[152:155], a[44:47], a[148:151], v[152:155]
v_add_f32 v21, v21, v61
v_add_f32 v22, v22, v62
v_mfma_f32_16x16x32_bf16 v[156:159], a[48:51], a[148:151], v[156:159]
v_add_f32 v23, v23, v63
v_add_f32 v24, v24, v64
v_mfma_f32_16x16x32_bf16 v[160:163], a[52:55], a[148:151], v[160:163]
v_add_f32 v25, v25, v65
v_add_f32 v26, v26, v66
v_mfma_f32_16x16x32_bf16 v[164:167], a[56:59], a[148:151], v[164:167]
s_waitcnt vmcnt(9)
s_load_dword s56, s[44:45], s28
s_load_dword s57, s[44:45], s29
s_load_dword s58, s[44:45], s30
s_load_dword s21, s[44:45], s26
v_add_f32 v27, v27, v67
v_add_f32 v28, v28, v68
v_mfma_f32_16x16x32_bf16 v[148:151], a[60:63], a[152:155], v[148:151]
buffer_load_dwordx4 a[192:195], v10, s[44:47], s9 offen sc1
v_mfma_f32_16x16x32_bf16 v[152:155], a[64:67], a[152:155], v[152:155]
v_add_f32 v29, v29, v69
v_add_f32 v30, v30, v70
v_mfma_f32_16x16x32_bf16 v[156:159], a[68:71], a[152:155], v[156:159]
v_add_f32 v31, v31, v71
v_add_f32 v32, v32, v72
v_mfma_f32_16x16x32_bf16 v[160:163], a[72:75], a[152:155], v[160:163]
v_add_f32 v33, v33, v73
v_add_f32 v34, v34, v74
v_mfma_f32_16x16x32_bf16 v[164:167], a[76:79], a[152:155], v[164:167]
s_waitcnt vmcnt(9)
v_add_f32 v35, v35, v75
v_add_f32 v36, v36, v76
v_mfma_f32_16x16x32_bf16 v[148:151], a[80:83], a[156:159], v[148:151]
s_add_u32 s10, s10, s12
v_add_f32 v37, v37, v77
v_mfma_f32_16x16x32_bf16 v[152:155], a[84:87], a[156:159], v[152:155]
buffer_load_dwordx4 a[196:199], v4, s[44:47], s10 offen sc1
v_mfma_f32_16x16x32_bf16 v[156:159], a[88:91], a[156:159], v[156:159]
v_add_f32 v38, v38, v78
v_add_f32 v39, v39, v79
v_mfma_f32_16x16x32_bf16 v[160:163], a[92:95], a[156:159], v[160:163]
v_add_f32 v84, v84, v20
v_add_f32 v85, v85, v21
v_mfma_f32_16x16x32_bf16 v[164:167], a[96:99], a[156:159], v[164:167]
s_waitcnt vmcnt(9)
v_cvt_pk_bf16_f32 v104, v84, v85
v_add_f32 v86, v86, v22
v_mfma_f32_16x16x32_bf16 v[148:151], a[100:103], a[160:163], v[148:151]
buffer_load_dwordx4 a[200:203], v5, s[44:47], s10 offen sc1
v_mfma_f32_16x16x32_bf16 v[152:155], a[104:107], a[160:163], v[152:155]
v_add_f32 v87, v87, v23
v_cvt_pk_bf16_f32 v105, v86, v87
v_mfma_f32_16x16x32_bf16 v[156:159], a[108:111], a[160:163], v[156:159]
v_add_f32 v88, v88, v24
v_add_f32 v89, v89, v25
v_mfma_f32_16x16x32_bf16 v[160:163], a[112:115], a[160:163], v[160:163]
v_cvt_pk_bf16_f32 v106, v88, v89
v_add_f32 v90, v90, v26
v_mfma_f32_16x16x32_bf16 v[164:167], a[116:119], a[160:163], v[164:167]
s_waitcnt vmcnt(9)
v_add_f32 v91, v91, v27
v_cvt_pk_bf16_f32 v107, v90, v91
v_mfma_f32_16x16x32_bf16 v[148:151], a[120:123], a[164:167], v[148:151]
buffer_load_dwordx4 a[204:207], v6, s[44:47], s10 offen sc1
v_mfma_f32_16x16x32_bf16 v[152:155], a[124:127], a[164:167], v[152:155]
buffer_store_dwordx4 v[104:107], v18, s[44:47], s18 offen sc1
v_mfma_f32_16x16x32_bf16 v[156:159], a[128:131], a[164:167], v[156:159]
v_add_f32 v92, v92, v28
v_add_f32 v93, v93, v29
v_mfma_f32_16x16x32_bf16 v[160:163], a[132:135], a[164:167], v[160:163]
v_cvt_pk_bf16_f32 v108, v92, v93
v_add_f32 v94, v94, v30
v_mfma_f32_16x16x32_bf16 v[164:167], a[136:139], a[164:167], v[164:167]
s_waitcnt vmcnt(10)
v_add_f32 v95, v95, v31
v_cvt_pk_bf16_f32 v109, v94, v95
v_mfma_f32_16x16x32_bf16 v[168:171], a[0:3], a[168:171], 0
buffer_load_dwordx4 a[208:211], v7, s[44:47], s10 offen sc1
v_mfma_f32_16x16x32_bf16 v[172:175], a[4:7], a[168:171], 0
v_add_f32 v96, v96, v32
v_add_f32 v97, v97, v33
v_mfma_f32_16x16x32_bf16 v[176:179], a[8:11], a[168:171], 0
v_add_u32 v117, s13, v18
v_add_u32 v117, 61440, v117
v_mfma_f32_16x16x32_bf16 v[180:183], a[12:15], a[168:171], 0
v_cvt_pk_bf16_f32 v110, v96, v97
v_add_f32 v98, v98, v34
v_mfma_f32_16x16x32_bf16 v[184:187], a[16:19], a[168:171], 0
s_waitcnt vmcnt(10)
v_add_f32 v99, v99, v35
v_cvt_pk_bf16_f32 v111, v98, v99
v_mfma_f32_16x16x32_bf16 v[168:171], a[20:23], a[172:175], v[168:171]
buffer_load_dwordx4 a[212:215], v8, s[44:47], s10 offen sc1
v_mfma_f32_16x16x32_bf16 v[172:175], a[24:27], a[172:175], v[172:175]
buffer_store_dwordx4 v[108:111], v18, s[44:47], s18 offen offset:1024 sc1
v_mfma_f32_16x16x32_bf16 v[176:179], a[28:31], a[172:175], v[176:179]
ds_write_b128 v117, v[148:151] offset:0
v_mfma_f32_16x16x32_bf16 v[180:183], a[32:35], a[172:175], v[180:183]
v_add_f32 v100, v100, v36
v_add_f32 v101, v101, v37
v_mfma_f32_16x16x32_bf16 v[184:187], a[36:39], a[172:175], v[184:187]
s_waitcnt vmcnt(11)
s_waitcnt lgkmcnt(0)
s_cmp_eq_u32 s21, 1
s_cbranch_scc0 LS_f4
LR_f4:
s_cmp_eq_u32 s56, 32
s_cbranch_scc0 LS_f30
LR_f30:
s_cmp_eq_u32 s57, 32
s_cbranch_scc0 LS_f31
LR_f31:
s_cmp_eq_u32 s58, 32
s_cbranch_scc0 LS_f32
LR_f32:
v_cvt_pk_bf16_f32 v112, v100, v101
v_add_f32 v102, v102, v38
v_mfma_f32_16x16x32_bf16 v[168:171], a[40:43], a[176:179], v[168:171]
buffer_load_dwordx4 a[216:219], v9, s[44:47], s10 offen sc1
v_mfma_f32_16x16x32_bf16 v[172:175], a[44:47], a[176:179], v[172:175]
ds_write_b128 v117, v[152:155] offset:1024
v_mfma_f32_16x16x32_bf16 v[176:179], a[48:51], a[176:179], v[176:179]
v_add_f32 v103, v103, v39
v_cvt_pk_bf16_f32 v113, v102, v103
v_mfma_f32_16x16x32_bf16 v[180:183], a[52:55], a[176:179], v[180:183]
buffer_store_dwordx2 v[112:113], v235, s[44:47], s18 offen offset:2048 sc1
v_mfma_f32_16x16x32_bf16 v[184:187], a[56:59], a[176:179], v[184:187]
s_waitcnt vmcnt(12)
v_mfma_f32_16x16x32_bf16 v[168:171], a[60:63], a[180:183], v[168:171]
buffer_load_dwordx4 a[220:223], v10, s[44:47], s10 offen sc1
v_mfma_f32_16x16x32_bf16 v[172:175], a[64:67], a[180:183], v[172:175]
ds_write_b128 v117, v[156:159] offset:2048
v_mfma_f32_16x16x32_bf16 v[176:179], a[68:71], a[180:183], v[176:179]
ds_read_b64 v[118:119], v231 offset:0
v_mfma_f32_16x16x32_bf16 v[180:183], a[72:75], a[180:183], v[180:183]
ds_read_b64 v[120:121], v231 offset:32
v_mfma_f32_16x16x32_bf16 v[184:187], a[76:79], a[180:183], v[184:187]
s_waitcnt vmcnt(12)
ds_write_b128 v117, v[160:163] offset:3072
v_mfma_f32_16x16x32_bf16 v[168:171], a[80:83], a[184:187], v[168:171]
ds_read_b64 v[122:123], v231 offset:64
s_add_u32 s11, s11, s12
v_mfma_f32_16x16x32_bf16 v[172:175], a[84:87], a[184:187], v[172:175]
buffer_load_dwordx4 a[224:227], v4, s[44:47], s11 offen sc1
v_mfma_f32_16x16x32_bf16 v[176:179], a[88:91], a[184:187], v[176:179]
ds_read_b64 v[124:125], v231 offset:96
v_mfma_f32_16x16x32_bf16 v[180:183], a[92:95], a[184:187], v[180:183]
ds_write_b128 v117, v[164:167] offset:4096
v_mfma_f32_16x16x32_bf16 v[184:187], a[96:99], a[184:187], v[184:187]
s_waitcnt vmcnt(12)
ds_read_b64 v[126:127], v231 offset:128
s_mov_b32 m0, s64
v_mfma_f32_16x16x32_bf16 v[168:171], a[100:103], a[188:191], v[168:171]
s_nop 0
buffer_load_dwordx4 a[228:231], v5, s[44:47], s11 offen sc1
v_mfma_f32_16x16x32_bf16 v[172:175], a[104:107], a[188:191], v[172:175]
buffer_load_dwordx4 v227, s[44:47], 0 offen sc1 lds
v_mfma_f32_16x16x32_bf16 v[176:179], a[108:111], a[188:191], v[176:179]
s_add_u32 m0, s64, 4096
s_nop 0
v_mfma_f32_16x16x32_bf16 v[180:183], a[112:115], a[188:191], v[180:183]
buffer_load_dwordx4 v227, s[44:47], s63 offen sc1 lds
v_mfma_f32_16x16x32_bf16 v[184:187], a[116:119], a[188:191], v[184:187]
s_waitcnt vmcnt(14)
s_mov_b32 m0, s65
s_nop 0
v_mfma_f32_16x16x32_bf16 v[168:171], a[120:123], a[192:195], v[168:171]
buffer_load_dwordx4 a[232:235], v6, s[44:47], s11 offen sc1
v_mfma_f32_16x16x32_bf16 v[172:175], a[124:127], a[192:195], v[172:175]
buffer_load_dwordx4 v227, s[44:47], s16 offen sc1 lds
v_mfma_f32_16x16x32_bf16 v[176:179], a[128:131], a[192:195], v[176:179]
v_mul_f32 v116, v114, v115
v_add_u32 v233, 61440, v233
v_mfma_f32_16x16x32_bf16 v[180:183], a[132:135], a[192:195], v[180:183]
s_waitcnt lgkmcnt(0)
v_lshlrev_b32 v128, 16, v118
v_and_b32 v129, 0xffff0000, v118
v_mfma_f32_16x16x32_bf16 v[184:187], a[136:139], a[192:195], v[184:187]
s_waitcnt vmcnt(15)
v_lshlrev_b32 v130, 16, v119
v_and_b32 v131, 0xffff0000, v119
v_mfma_f32_16x16x32_bf16 v[188:191], a[0:3], a[196:199], 0
buffer_load_dwordx4 a[236:239], v7, s[44:47], s11 offen sc1
v_mfma_f32_16x16x32_bf16 v[192:195], a[4:7], a[196:199], 0
v_lshlrev_b32 v132, 16, v120
v_and_b32 v133, 0xffff0000, v120
v_mfma_f32_16x16x32_bf16 v[196:199], a[8:11], a[196:199], 0
v_add_u32 v117, s14, v18
v_add_u32 v117, 61440, v117
v_mfma_f32_16x16x32_bf16 v[200:203], a[12:15], a[196:199], 0
v_lshlrev_b32 v134, 16, v121
v_and_b32 v135, 0xffff0000, v121
v_mfma_f32_16x16x32_bf16 v[204:207], a[16:19], a[196:199], 0
s_waitcnt vmcnt(15)
v_lshlrev_b32 v136, 16, v122
v_and_b32 v137, 0xffff0000, v122
v_mfma_f32_16x16x32_bf16 v[188:191], a[20:23], a[200:203], v[188:191]
buffer_load_dwordx4 a[240:243], v8, s[44:47], s11 offen sc1
v_mfma_f32_16x16x32_bf16 v[192:195], a[24:27], a[200:203], v[192:195]
v_lshlrev_b32 v138, 16, v123
v_and_b32 v139, 0xffff0000, v123
v_mfma_f32_16x16x32_bf16 v[196:199], a[28:31], a[200:203], v[196:199]
ds_write_b128 v117, v[168:171] offset:0
v_mfma_f32_16x16x32_bf16 v[200:203], a[32:35], a[200:203], v[200:203]
v_lshlrev_b32 v140, 16, v124
v_and_b32 v141, 0xffff0000, v124
v_mfma_f32_16x16x32_bf16 v[204:207], a[36:39], a[200:203], v[204:207]
s_waitcnt vmcnt(15)
v_lshlrev_b32 v142, 16, v125
v_and_b32 v143, 0xffff0000, v125
v_mfma_f32_16x16x32_bf16 v[188:191], a[40:43], a[204:207], v[188:191]
buffer_load_dwordx4 a[244:247], v9, s[44:47], s11 offen sc1
v_mfma_f32_16x16x32_bf16 v[192:195], a[44:47], a[204:207], v[192:195]
ds_write_b128 v117, v[172:175] offset:1024
v_mfma_f32_16x16x32_bf16 v[196:199], a[48:51], a[204:207], v[196:199]
v_lshlrev_b32 v144, 16, v126
v_and_b32 v145, 0xffff0000, v126
v_mfma_f32_16x16x32_bf16 v[200:203], a[52:55], a[204:207], v[200:203]
v_lshlrev_b32 v146, 16, v127
v_and_b32 v147, 0xffff0000, v127
v_mfma_f32_16x16x32_bf16 v[204:207], a[56:59], a[204:207], v[204:207]
s_waitcnt vmcnt(14)
v_fma_f32 v60, v128, v115, -v116
v_fma_f32 v61, v129, v115, -v116
v_mfma_f32_16x16x32_bf16 v[188:191], a[60:63], a[208:211], v[188:191]
buffer_load_dwordx4 a[248:251], v10, s[44:47], s11 offen sc1
v_mfma_f32_16x16x32_bf16 v[192:195], a[64:67], a[208:211], v[192:195]
ds_write_b128 v117, v[176:179] offset:2048
v_mfma_f32_16x16x32_bf16 v[196:199], a[68:71], a[208:211], v[196:199]
v_fma_f32 v62, v130, v115, -v116
v_fma_f32 v63, v131, v115, -v116
v_mfma_f32_16x16x32_bf16 v[200:203], a[72:75], a[208:211], v[200:203]
v_fma_f32 v64, v132, v115, -v116
v_fma_f32 v65, v133, v115, -v116
v_mfma_f32_16x16x32_bf16 v[204:207], a[76:79], a[208:211], v[204:207]
s_waitcnt vmcnt(14)
ds_write_b128 v117, v[180:183] offset:3072
v_mfma_f32_16x16x32_bf16 v[188:191], a[80:83], a[212:215], v[188:191]
v_fma_f32 v66, v134, v115, -v116
v_fma_f32 v67, v135, v115, -v116
v_mfma_f32_16x16x32_bf16 v[192:195], a[84:87], a[212:215], v[192:195]
v_fma_f32 v68, v136, v115, -v116
v_fma_f32 v69, v137, v115, -v116
v_mfma_f32_16x16x32_bf16 v[196:199], a[88:91], a[212:215], v[196:199]
v_fma_f32 v70, v138, v115, -v116
v_fma_f32 v71, v139, v115, -v116
v_mfma_f32_16x16x32_bf16 v[200:203], a[92:95], a[212:215], v[200:203]
ds_write_b128 v117, v[184:187] offset:4096
v_mfma_f32_16x16x32_bf16 v[204:207], a[96:99], a[212:215], v[204:207]
s_waitcnt vmcnt(12)
v_fma_f32 v72, v140, v115, -v116
v_fma_f32 v73, v141, v115, -v116
v_mfma_f32_16x16x32_bf16 v[188:191], a[100:103], a[216:219], v[188:191]
v_fma_f32 v74, v142, v115, -v116
v_fma_f32 v75, v143, v115, -v116
v_mfma_f32_16x16x32_bf16 v[192:195], a[104:107], a[216:219], v[192:195]
v_fma_f32 v76, v144, v115, -v116
v_fma_f32 v77, v145, v115, -v116
v_mfma_f32_16x16x32_bf16 v[196:199], a[108:111], a[216:219], v[196:199]
v_fma_f32 v78, v146, v115, -v116
v_fma_f32 v79, v147, v115, -v116
v_mfma_f32_16x16x32_bf16 v[200:203], a[112:115], a[216:219], v[200:203]
v_mfma_f32_16x16x32_bf16 v[204:207], a[116:119], a[216:219], v[204:207]
s_waitcnt vmcnt(10) lgkmcnt(0)
s_barrier
buffer_load_dwordx4 v[104:107], v18, s[44:47], s19 offen sc1
v_mfma_f32_16x16x32_bf16 v[188:191], a[120:123], a[220:223], v[188:191]
ds_read_b128 v[20:23], v233 offset:0
v_mfma_f32_16x16x32_bf16 v[192:195], a[124:127], a[220:223], v[192:195]
buffer_load_dwordx4 v[108:111], v18, s[44:47], s19 offen offset:1024 sc1
v_mfma_f32_16x16x32_bf16 v[196:199], a[128:131], a[220:223], v[196:199]
ds_read_b128 v[24:27], v233 offset:1024
v_mfma_f32_16x16x32_bf16 v[200:203], a[132:135], a[220:223], v[200:203]
buffer_load_dwordx2 v[112:113], v235, s[44:47], s19 offen offset:2048 sc1
v_mfma_f32_16x16x32_bf16 v[204:207], a[136:139], a[220:223], v[204:207]
s_waitcnt vmcnt(12)
ds_read_b128 v[28:31], v233 offset:2048
v_mfma_f32_16x16x32_bf16 v[84:87], a[0:3], a[224:227], 0
ds_read_b128 v[32:35], v233 offset:3072
v_mfma_f32_16x16x32_bf16 v[88:91], a[4:7], a[224:227], 0
ds_read_b128 v[36:39], v233 offset:4096
v_mfma_f32_16x16x32_bf16 v[92:95], a[8:11], a[224:227], 0
ds_read_b128 v[40:43], v233 offset:5120
v_add_u32 v117, s15, v18
v_mfma_f32_16x16x32_bf16 v[96:99], a[12:15], a[224:227], 0
ds_read_b128 v[44:47], v233 offset:6144
v_add_u32 v117, 61440, v117
v_mfma_f32_16x16x32_bf16 v[100:103], a[16:19], a[224:227], 0
s_waitcnt vmcnt(11)
ds_read_b128 v[48:51], v233 offset:7168
v_mfma_f32_16x16x32_bf16 v[84:87], a[20:23], a[228:231], v[84:87]
ds_read_b128 v[52:55], v233 offset:8192
v_mfma_f32_16x16x32_bf16 v[88:91], a[24:27], a[228:231], v[88:91]
ds_read_b128 v[56:59], v233 offset:9216
v_mfma_f32_16x16x32_bf16 v[92:95], a[28:31], a[228:231], v[92:95]
ds_write_b128 v117, v[188:191] offset:0
v_mfma_f32_16x16x32_bf16 v[96:99], a[32:35], a[228:231], v[96:99]
v_mfma_f32_16x16x32_bf16 v[100:103], a[36:39], a[228:231], v[100:103]
s_waitcnt vmcnt(8)
v_mfma_f32_16x16x32_bf16 v[84:87], a[40:43], a[232:235], v[84:87]
ds_write_b128 v117, v[192:195] offset:1024
v_mfma_f32_16x16x32_bf16 v[88:91], a[44:47], a[232:235], v[88:91]
s_waitcnt lgkmcnt(2)
v_add_f32 v20, v20, v40
v_add_f32 v21, v21, v41
v_mfma_f32_16x16x32_bf16 v[92:95], a[48:51], a[232:235], v[92:95]
v_add_f32 v22, v22, v42
v_add_f32 v23, v23, v43
v_mfma_f32_16x16x32_bf16 v[96:99], a[52:55], a[232:235], v[96:99]
ds_write_b128 v117, v[196:199] offset:2048
v_mfma_f32_16x16x32_bf16 v[100:103], a[56:59], a[232:235], v[100:103]
s_waitcnt vmcnt(6)
v_add_f32 v24, v24, v44
v_add_f32 v25, v25, v45
v_mfma_f32_16x16x32_bf16 v[84:87], a[60:63], a[236:239], v[84:87]
v_add_f32 v26, v26, v46
v_add_f32 v27, v27, v47
v_mfma_f32_16x16x32_bf16 v[88:91], a[64:67], a[236:239], v[88:91]
ds_write_b128 v117, v[200:203] offset:3072
v_mfma_f32_16x16x32_bf16 v[92:95], a[68:71], a[236:239], v[92:95]
v_add_f32 v28, v28, v48
v_add_f32 v29, v29, v49
v_mfma_f32_16x16x32_bf16 v[96:99], a[72:75], a[236:239], v[96:99]
v_add_f32 v30, v30, v50
v_add_f32 v31, v31, v51
v_mfma_f32_16x16x32_bf16 v[100:103], a[76:79], a[236:239], v[100:103]
s_waitcnt vmcnt(5)
ds_write_b128 v117, v[204:207] offset:4096
v_mfma_f32_16x16x32_bf16 v[84:87], a[80:83], a[240:243], v[84:87]
v_add_f32 v32, v32, v52
v_add_f32 v33, v33, v53
v_mfma_f32_16x16x32_bf16 v[88:91], a[84:87], a[240:243], v[88:91]
v_add_f32 v34, v34, v54
v_add_f32 v35, v35, v55
v_mfma_f32_16x16x32_bf16 v[92:95], a[88:91], a[240:243], v[92:95]
v_add_f32 v36, v36, v56
v_add_f32 v37, v37, v57
v_mfma_f32_16x16x32_bf16 v[96:99], a[92:95], a[240:243], v[96:99]
v_add_f32 v38, v38, v58
v_add_f32 v39, v39, v59
v_mfma_f32_16x16x32_bf16 v[100:103], a[96:99], a[240:243], v[100:103]
s_waitcnt lgkmcnt(0)
s_barrier
s_waitcnt vmcnt(4)
ds_read_b64_tr_b16 v[118:119], v229 offset:0
v_mfma_f32_16x16x32_bf16 v[84:87], a[100:103], a[244:247], v[84:87]
ds_read_b64_tr_b16 v[120:121], v229 offset:2048
v_mfma_f32_16x16x32_bf16 v[88:91], a[104:107], a[244:247], v[88:91]
ds_read_b64_tr_b16 v[122:123], v229 offset:4096
v_mfma_f32_16x16x32_bf16 v[92:95], a[108:111], a[244:247], v[92:95]
ds_read_b64_tr_b16 v[124:125], v229 offset:6144
v_mfma_f32_16x16x32_bf16 v[96:99], a[112:115], a[244:247], v[96:99]
ds_read_b64_tr_b16 v[126:127], v229 offset:8192
v_mfma_f32_16x16x32_bf16 v[100:103], a[116:119], a[244:247], v[100:103]
s_waitcnt vmcnt(3)
ds_read_b128 v[148:151], v233 offset:10240
v_mfma_f32_16x16x32_bf16 v[84:87], a[120:123], a[248:251], v[84:87]
ds_read_b128 v[152:155], v233 offset:11264
v_mfma_f32_16x16x32_bf16 v[88:91], a[124:127], a[248:251], v[88:91]
ds_read_b128 v[156:159], v233 offset:12288
v_mfma_f32_16x16x32_bf16 v[92:95], a[128:131], a[248:251], v[92:95]
ds_read_b128 v[160:163], v233 offset:13312
v_mfma_f32_16x16x32_bf16 v[96:99], a[132:135], a[248:251], v[96:99]
s_waitcnt lgkmcnt(4)
ds_read_b128 v[164:167], v233 offset:14336
v_pk_max_u16 v14, v118, v119
v_mfma_f32_16x16x32_bf16 v[100:103], a[136:139], a[248:251], v[100:103]
v_pk_max_u16 v15, v120, v121
v_pk_max_u16 v14, v14, v122
v_pk_max_u16 v15, v15, v123
v_pk_max_u16 v14, v14, v124
v_pk_max_u16 v15, v15, v125
v_pk_max_u16 v14, v14, v126
v_pk_max_u16 v15, v15, v127
v_pk_max_u16 v14, v14, v15
v_pk_max_u16 v14, v14, v14 op_sel:[1,0] op_sel_hi:[0,1]
s_mov_b32 s62, 0xbf317218
v_add_u32 v17, s17, v18
v_cmp_eq_u32 vcc, -1, v14
s_nop 0
s_cbranch_vccnz LS_y
LR_y:
v_lshlrev_b32 v14, 16, v118
v_and_b32 v15, 0xffff0000, v118
v_pk_fma_f32 v[128:129], v[60:61], v[14:15], v[128:129]
v_lshlrev_b32 v14, 16, v119
v_and_b32 v15, 0xffff0000, v119
v_pk_fma_f32 v[130:131], v[62:63], v[14:15], v[130:131]
v_lshlrev_b32 v14, 16, v120
v_and_b32 v15, 0xffff0000, v120
v_pk_fma_f32 v[132:133], v[64:65], v[14:15], v[132:133]
v_lshlrev_b32 v14, 16, v121
v_and_b32 v15, 0xffff0000, v121
v_pk_fma_f32 v[134:135], v[66:67], v[14:15], v[134:135]
v_lshlrev_b32 v14, 16, v122
v_and_b32 v15, 0xffff0000, v122
v_pk_fma_f32 v[136:137], v[68:69], v[14:15], v[136:137]
v_lshlrev_b32 v14, 16, v123
v_and_b32 v15, 0xffff0000, v123
v_pk_fma_f32 v[138:139], v[70:71], v[14:15], v[138:139]
v_lshlrev_b32 v14, 16, v124
v_and_b32 v15, 0xffff0000, v124
v_pk_fma_f32 v[140:141], v[72:73], v[14:15], v[140:141]
v_lshlrev_b32 v14, 16, v125
v_and_b32 v15, 0xffff0000, v125
v_pk_fma_f32 v[142:143], v[74:75], v[14:15], v[142:143]
v_lshlrev_b32 v14, 16, v126
v_and_b32 v15, 0xffff0000, v126
v_pk_fma_f32 v[144:145], v[76:77], v[14:15], v[144:145]
v_lshlrev_b32 v14, 16, v127
v_and_b32 v15, 0xffff0000, v127
v_pk_fma_f32 v[146:147], v[78:79], v[14:15], v[146:147]
s_waitcnt lgkmcnt(0)
.p2align 3
v_pk_add_f32 v[20:21], v[20:21], v[148:149]
v_pk_add_f32 v[22:23], v[22:23], v[150:151]
v_pk_add_f32 v[24:25], v[24:25], v[152:153]
v_pk_add_f32 v[26:27], v[26:27], v[154:155]
v_pk_add_f32 v[28:29], v[28:29], v[156:157]
v_pk_add_f32 v[30:31], v[30:31], v[158:159]
v_pk_add_f32 v[32:33], v[32:33], v[160:161]
v_pk_add_f32 v[34:35], v[34:35], v[162:163]
v_pk_add_f32 v[36:37], v[36:37], v[164:165]
v_pk_add_f32 v[38:39], v[38:39], v[166:167]
v_pk_add_f32 v[84:85], v[84:85], v[20:21]
v_pk_add_f32 v[86:87], v[86:87], v[22:23]
v_pk_add_f32 v[88:89], v[88:89], v[24:25]
v_pk_add_f32 v[90:91], v[90:91], v[26:27]
v_pk_add_f32 v[92:93], v[92:93], v[28:29]
v_pk_add_f32 v[94:95], v[94:95], v[30:31]
v_pk_add_f32 v[96:97], v[96:97], v[32:33]
v_pk_add_f32 v[98:99], v[98:99], v[34:35]
v_pk_add_f32 v[100:101], v[100:101], v[36:37]
v_pk_add_f32 v[102:103], v[102:103], v[38:39]
s_waitcnt vmcnt(0)
v_max3_u32 v20, v104, v105, v106
v_max3_u32 v21, v107, v108, v109
v_max3_u32 v20, v20, v110, v111
v_max3_u32 v21, v21, v112, v113
v_max_u32 v20, v20, v21
v_cmp_eq_u32 vcc, -1, v20
s_nop 0
s_cbranch_vccnz LS_p
LR_p:
v_lshlrev_b32 v20, 16, v112
v_and_b32 v21, 0xffff0000, v112
v_pk_add_f32 v[100:101], v[100:101], v[20:21]
v_pk_fma_f32 v[100:101], v[100:101], s[62:63], v[144:145] op_sel_hi:[1,0,1]
v_cvt_pk_bf16_f32 v32, v100, v101
v_lshlrev_b32 v22, 16, v113
v_and_b32 v23, 0xffff0000, v113
v_pk_add_f32 v[102:103], v[102:103], v[22:23]
v_pk_fma_f32 v[102:103], v[102:103], s[62:63], v[146:147] op_sel_hi:[1,0,1]
v_cvt_pk_bf16_f32 v33, v102, v103
buffer_store_dwordx2 v[32:33], v230, s[36:39], 0 offen offset:128
v_lshlrev_b32 v20, 16, v104
v_and_b32 v21, 0xffff0000, v104
v_pk_add_f32 v[84:85], v[84:85], v[20:21]
v_pk_fma_f32 v[84:85], v[84:85], s[62:63], v[128:129] op_sel_hi:[1,0,1]
v_cvt_pk_bf16_f32 v24, v84, v85
v_lshlrev_b32 v22, 16, v105
v_and_b32 v23, 0xffff0000, v105
v_pk_add_f32 v[86:87], v[86:87], v[22:23]
v_pk_fma_f32 v[86:87], v[86:87], s[62:63], v[130:131] op_sel_hi:[1,0,1]
v_cvt_pk_bf16_f32 v25, v86, v87
v_lshlrev_b32 v20, 16, v106
v_and_b32 v21, 0xffff0000, v106
v_pk_add_f32 v[88:89], v[88:89], v[20:21]
v_pk_fma_f32 v[88:89], v[88:89], s[62:63], v[132:133] op_sel_hi:[1,0,1]
v_cvt_pk_bf16_f32 v26, v88, v89
v_lshlrev_b32 v22, 16, v107
v_and_b32 v23, 0xffff0000, v107
v_pk_add_f32 v[90:91], v[90:91], v[22:23]
v_pk_fma_f32 v[90:91], v[90:91], s[62:63], v[134:135] op_sel_hi:[1,0,1]
v_cvt_pk_bf16_f32 v27, v90, v91
v_lshlrev_b32 v20, 16, v108
v_and_b32 v21, 0xffff0000, v108
v_pk_add_f32 v[92:93], v[92:93], v[20:21]
v_pk_fma_f32 v[92:93], v[92:93], s[62:63], v[136:137] op_sel_hi:[1,0,1]
v_cvt_pk_bf16_f32 v28, v92, v93
v_permlane16_swap_b32 v24, v26
v_permlane16_swap_b32 v25, v27
buffer_store_dwordx4 v[24:27], v228, s[36:39], 0 offen offset:0
v_lshlrev_b32 v22, 16, v109
v_and_b32 v23, 0xffff0000, v109
v_pk_add_f32 v[94:95], v[94:95], v[22:23]
v_pk_fma_f32 v[94:95], v[94:95], s[62:63], v[138:139] op_sel_hi:[1,0,1]
v_cvt_pk_bf16_f32 v29, v94, v95
v_lshlrev_b32 v20, 16, v110
v_and_b32 v21, 0xffff0000, v110
v_pk_add_f32 v[96:97], v[96:97], v[20:21]
v_pk_fma_f32 v[96:97], v[96:97], s[62:63], v[140:141] op_sel_hi:[1,0,1]
v_cvt_pk_bf16_f32 v30, v96, v97
v_lshlrev_b32 v22, 16, v111
v_and_b32 v23, 0xffff0000, v111
v_pk_add_f32 v[98:99], v[98:99], v[22:23]
v_pk_fma_f32 v[98:99], v[98:99], s[62:63], v[142:143] op_sel_hi:[1,0,1]
v_cvt_pk_bf16_f32 v31, v98, v99
s_nop 1
v_permlane16_swap_b32 v28, v30
v_permlane16_swap_b32 v29, v31
buffer_store_dwordx4 v[28:31], v228, s[36:39], 0 offen offset:64
L_end:
s_endpgm
L_A2:
s_load_dwordx2 s[20:21], s[0:1], 32
s_load_dwordx2 s[24:25], s[0:1], 40
s_load_dwordx2 s[36:37], s[0:1], 72
s_load_dwordx2 s[40:41], s[0:1], 80
s_mov_b32 s22, 2621440
s_mov_b32 s23, 0x20000
s_mov_b32 s26, 1280
s_mov_b32 s27, 0x20000
s_mov_b32 s38, 2621440
s_mov_b32 s39, 0x20000
s_mov_b32 s42, 256
s_mov_b32 s43, 0x20000
s_mov_b32 s34, 2211840
s_mov_b32 s35, 0x20000
v_lshlrev_b32 v18, 4, v1
v_mov_b32 v3, 1
v_min_u32 v2, 1, v0
v_lshlrev_b32 v2, 31, v2
s_lshr_b32 s3, s49, 3
s_add_u32 s53, s62, s3
s_and_b32 s54, s49, 7
s_mul_i32 s55, s48, 80
s_lshr_b32 s3, s49, 1
s_mul_i32 s3, s3, 5
s_add_u32 s55, s55, s3
v_and_b32 v20, 15, v1
v_xor_b32 v20, 15, v20
v_lshrrev_b32 v21, 4, v0
v_mul_u32_u24 v9, 1040, v20
v_lshl_add_u32 v9, v21, 3, v9
v_lshlrev_b32 v10, 5, v21
v_add_u32 v10, 106080, v10
v_lshlrev_b32 v20, 4, v20
v_lshlrev_b32 v11, 14, v21
v_sub_u32 v11, v11, v20
s_mul_i32 s69, s75, 5
s_lshl_b32 s59, s69, 18
s_lshl_b32 s3, s51, 8
s_sub_u32 s59, s59, s3
s_add_u32 s59, s59, 4080
v_add_u32 v11, s59, v11
v_add_u32 v12, 4096, v11
v_add_u32 v13, 8192, v11
v_add_u32 v14, 12288, v11
v_add_u32 v20, s69, v0
v_lshlrev_b32 v20, 7, v20
v_add_u32 v20, 5291008, v20
v_cmp_gt_u32 vcc, 3, v0
v_mov_b32 v242, 2
v_mov_b32 v21, 2147483648
s_mov_b32 s59, 0
v_cndmask_b32 v254, v21, v20, vcc
s_lshl_b32 s3, s51, 10
s_add_u32 s3, s3, 5242880
v_and_b32 v20, 7, v1
v_lshl_add_u32 v15, v20, 7, s3

s_and_b32 s3, s49, 1
s_lshl_b32 s3, s3, 1
s_add_u32 s3, s3, s55
s_lshl_b32 s72, s3, 12
s_add_u32 s73, s72, 4096
s_add_u32 s3, s55, 4
s_lshl_b32 s74, s3, 12
v_lshrrev_b32 v20, 2, v1
v_min_u32 v20, 2, v20
v_min_u32 v21, 1, v20
v_lshl_add_u32 v239, v21, 12, s72
v_lshrrev_b32 v21, 1, v20
s_sub_u32 s3, s74, s73
v_mad_u32_u24 v239, v21, s3, v239
v_mul_u32_u24 v20, 21248, v20
v_and_b32 v21, 3, v1
v_mul_u32_u24 v21, 4162, v21
s_min_u32 s3, s50, 1
s_mul_i32 s3, s3, 4098
s_add_u32 s3, s3, 98336
v_add3_u32 v240, v20, v21, s3
s_lshr_b32 s3, s49, 3
s_mul_i32 s60, s3, 2
s_mul_i32 s3, s75, 28
s_mul_i32 s62, s50, 7
s_add_u32 s3, s3, s62
s_mul_i32 s3, s3, 40960
s_lshl_b32 s62, s54, 7
s_add_u32 s3, s3, s62
v_lshrrev_b32 v20, 3, v1
v_and_b32 v21, 6, v20
v_and_b32 v22, 7, v1
v_xor_b32 v21, v21, v22
v_lshlrev_b32 v21, 4, v21
v_mul_u32_u24 v20, 1280, v20
v_add3_u32 v244, v20, v21, s3
v_add_u32 v245, 9216, v244
v_add_u32 v246, 18432, v244
v_add_u32 v247, 27648, v244
s_and_b32 s66, s50, 1
s_lshr_b32 s67, s50, 1
s_lshl_b32 s70, s50, 12
v_add_u32 v219, 98304, v19
v_and_b32 v20, 15, v1
v_lshrrev_b32 v21, 4, v1
v_sub_u32 v22, 15, v20
v_and_b32 v214, 3, v22
v_mul_u32_u24 v214, 4160, v214
v_lshrrev_b32 v23, 2, v22
v_lshlrev_b32 v23, 3, v23
v_sub_u32 v214, v214, v23
v_lshl_add_u32 v214, v21, 4, v214
v_lshlrev_b32 v215, 5, v20
v_sub_u32 v215, 17088, v215
v_lshl_add_u32 v215, v21, 4, v215
s_mul_i32 s3, s67, 21248
s_lshl_b32 s62, s66, 8
s_add_u32 s3, s3, s62
s_add_u32 s3, s3, 98336
v_add_u32 v212, s3, v214
v_add_u32 v213, s3, v215
s_lshl_b32 s3, s50, 7
s_add_u32 s3, s3, 140832
v_add_u32 v214, s3, v214
v_add_u32 v215, s3, v215
s_add_u32 s3, s70, 0
v_add_u32 v216, s3, v18
s_lshl_b32 s3, s50, 10
s_add_u32 s3, s3, 0
v_add_u32 v220, s3, v18
v_lshlrev_b32 v221, 5, v20
v_lshl_add_u32 v221, v21, 3, v221
s_lshl_b32 s3, s67, 2
s_bitcmp1_b32 s49, 0
s_cselect_b32 s3, 2, s3
s_add_u32 s3, s3, s50
s_lshl_b32 s3, s3, 9
s_add_u32 s3, s3, s74
s_add_u32 s3, s3, 2621440
v_add_u32 v221, s3, v221
s_lshr_b32 s3, s55, 6
s_lshl_b32 s3, s3, 7
s_add_u32 s66, s3, 5291008
s_add_u32 s3, s55, 4
s_lshr_b32 s3, s3, 6
s_lshl_b32 s3, s3, 7
s_add_u32 s67, s3, 5291008
s_sub_u32 s62, s67, s66
v_lshrrev_b32 v23, 5, v1
v_mul_u32_u24 v22, s62, v23
v_add_u32 v238, s66, v22
s_mul_i32 s71, s60, 40960
s_mov_b32 s68, 0
s_mul_i32 s3, s54, 56
s_mul_i32 s62, s75, 28
s_add_u32 s3, s3, s62
s_mul_i32 s62, s50, 7
s_add_u32 s3, s3, s62
s_lshl_b32 s3, s3, 10
s_add_u32 s17, s3, 16777216
v_bfe_u32 v20, v1, 3, 2
v_lshlrev_b32 v20, 5, v20
v_lshrrev_b32 v249, 2, v1
v_lshl_add_u32 v20, v249, 7, v20
v_and_b32 v249, 3, v1
v_lshl_add_u32 v20, v249, 3, v20
s_add_u32 s3, s70, 16384
v_add_u32 v248, s3, v20
v_xor_b32 v249, 32, v248
v_xor_b32 v236, 64, v248
v_xor_b32 v243, 96, v248
s_add_u32 m0, s57, 35360
s_mov_b32 s58, 128
buffer_load_dwordx4 v8, s[8:11], s58 offen lds
s_add_u32 m0, s56, 36400
s_nop 0
buffer_load_dwordx4 v4, s[8:11], s58 offen offset:0 nt lds
buffer_load_dwordx4 v5, s[8:11], s58 offen offset:1040 nt lds
buffer_load_dwordx4 v6, s[8:11], s58 offen offset:2080 nt lds
buffer_load_dwordx4 v7, s[8:11], s58 offen offset:3120 nt lds
s_add_u32 m0, s56, 53040
s_nop 0
buffer_load_dwordx4 v4, s[12:15], s58 offen offset:0 nt lds
buffer_load_dwordx4 v5, s[12:15], s58 offen offset:1040 nt lds
buffer_load_dwordx4 v6, s[12:15], s58 offen offset:2080 nt lds
buffer_load_dwordx4 v7, s[12:15], s58 offen offset:3120 nt lds
s_waitcnt vmcnt(9) lgkmcnt(0)
s_barrier
ds_read_b128 v[62:65], v10 offset:0
ds_read_b128 v[66:69], v10 offset:16
ds_read_b64 v[24:25], v9 offset:640
ds_read_b64 v[26:27], v9 offset:768
ds_read_b64 v[28:29], v9 offset:896
ds_read_b64 v[30:31], v9 offset:1040
ds_read_b64 v[32:33], v9 offset:1168
ds_read_b64 v[34:35], v9 offset:1296
ds_read_b64 v[36:37], v9 offset:1424
ds_read_b64 v[38:39], v9 offset:1552
ds_read_b64 v[40:41], v9 offset:1680
ds_read_b64 v[42:43], v9 offset:1808
ds_read_b64 v[44:45], v9 offset:1936
LA_loop:
s_waitcnt lgkmcnt(0)
ds_read_b64 v[46:47], v9 offset:17680
ds_read_b64 v[48:49], v9 offset:17808
ds_read_b64 v[50:51], v9 offset:17936
ds_read_b64 v[52:53], v9 offset:18064
ds_read_b64 v[54:55], v9 offset:18192
ds_read_b64 v[56:57], v9 offset:18320
ds_read_b64 v[58:59], v9 offset:18448
ds_read_b64 v[60:61], v9 offset:18576
s_cmp_eq_u32 s59, 0
s_cbranch_scc0 LA_k0
s_add_u32 m0, s57, 70720
s_mov_b32 s58, 256
buffer_load_dwordx4 v8, s[8:11], s58 offen lds
s_add_u32 m0, s56, 71760
s_nop 0
buffer_load_dwordx4 v4, s[8:11], s58 offen offset:0 nt lds
buffer_load_dwordx4 v5, s[8:11], s58 offen offset:1040 nt lds
buffer_load_dwordx4 v6, s[8:11], s58 offen offset:2080 nt lds
buffer_load_dwordx4 v7, s[8:11], s58 offen offset:3120 nt lds
LA_k0:
v_lshlrev_b32 v114, 16, v62
v_and_b32 v118, 0xffff0000, v62
v_lshlrev_b32 v122, 16, v63
v_and_b32 v126, 0xffff0000, v63
v_lshlrev_b32 v115, 16, v64
v_and_b32 v119, 0xffff0000, v64
v_lshlrev_b32 v123, 16, v65
v_and_b32 v127, 0xffff0000, v65
v_lshlrev_b32 v116, 16, v66
v_and_b32 v120, 0xffff0000, v66
v_lshlrev_b32 v124, 16, v67
v_and_b32 v128, 0xffff0000, v67
v_lshlrev_b32 v117, 16, v68
v_and_b32 v121, 0xffff0000, v68
v_lshlrev_b32 v125, 16, v69
v_and_b32 v129, 0xffff0000, v69
v_lshlrev_b32 v70, 16, v24
v_and_b32 v71, 0xffff0000, v24
v_lshlrev_b32 v72, 16, v25
v_and_b32 v73, 0xffff0000, v25
v_lshlrev_b32 v74, 16, v26
v_and_b32 v75, 0xffff0000, v26
v_lshlrev_b32 v76, 16, v27
v_and_b32 v77, 0xffff0000, v27
v_lshlrev_b32 v78, 16, v28
v_and_b32 v79, 0xffff0000, v28
v_lshlrev_b32 v80, 16, v29
v_and_b32 v81, 0xffff0000, v29
v_lshlrev_b32 v82, 16, v30
v_and_b32 v83, 0xffff0000, v30
v_lshlrev_b32 v84, 16, v31
v_and_b32 v85, 0xffff0000, v31
v_lshlrev_b32 v86, 16, v32
v_and_b32 v87, 0xffff0000, v32
v_lshlrev_b32 v88, 16, v33
v_and_b32 v89, 0xffff0000, v33
v_lshlrev_b32 v90, 16, v34
v_and_b32 v91, 0xffff0000, v34
v_lshlrev_b32 v92, 16, v35
v_and_b32 v93, 0xffff0000, v35
v_lshlrev_b32 v94, 16, v36
v_and_b32 v95, 0xffff0000, v36
v_lshlrev_b32 v96, 16, v37
v_and_b32 v97, 0xffff0000, v37
v_lshlrev_b32 v98, 16, v38
v_and_b32 v99, 0xffff0000, v38
v_lshlrev_b32 v100, 16, v39
v_and_b32 v101, 0xffff0000, v39
v_lshlrev_b32 v102, 16, v40
v_and_b32 v103, 0xffff0000, v40
v_lshlrev_b32 v104, 16, v41
v_and_b32 v105, 0xffff0000, v41
v_lshlrev_b32 v106, 16, v42
v_and_b32 v107, 0xffff0000, v42
v_lshlrev_b32 v108, 16, v43
v_and_b32 v109, 0xffff0000, v43
v_lshlrev_b32 v110, 16, v44
v_and_b32 v111, 0xffff0000, v44
v_lshlrev_b32 v112, 16, v45
v_and_b32 v113, 0xffff0000, v45
s_cmp_eq_u32 s59, 0
s_cbranch_scc0 LA_k1
s_add_u32 m0, s56, 88400
s_nop 0
buffer_load_dwordx4 v4, s[12:15], s58 offen offset:0 nt lds
buffer_load_dwordx4 v5, s[12:15], s58 offen offset:1040 nt lds
buffer_load_dwordx4 v6, s[12:15], s58 offen offset:2080 nt lds
buffer_load_dwordx4 v7, s[12:15], s58 offen offset:3120 nt lds
LA_k1:
.p2align 3
v_pk_mul_f32 v[130:131], v[82:83], v[114:115]
v_pk_mul_f32 v[132:133], v[84:85], v[116:117]
v_pk_fma_f32 v[130:131], v[78:79], v[118:119], v[130:131]
v_pk_fma_f32 v[132:133], v[80:81], v[120:121], v[132:133]
v_pk_fma_f32 v[130:131], v[74:75], v[122:123], v[130:131]
v_pk_fma_f32 v[132:133], v[76:77], v[124:125], v[132:133]
v_pk_fma_f32 v[130:131], v[70:71], v[126:127], v[130:131]
v_pk_fma_f32 v[132:133], v[72:73], v[128:129], v[132:133]
v_pk_mul_f32 v[134:135], v[86:87], v[114:115]
v_pk_mul_f32 v[136:137], v[88:89], v[116:117]
v_pk_fma_f32 v[134:135], v[82:83], v[118:119], v[134:135]
v_pk_fma_f32 v[136:137], v[84:85], v[120:121], v[136:137]
v_pk_fma_f32 v[134:135], v[78:79], v[122:123], v[134:135]
v_pk_fma_f32 v[136:137], v[80:81], v[124:125], v[136:137]
v_pk_fma_f32 v[134:135], v[74:75], v[126:127], v[134:135]
v_pk_fma_f32 v[136:137], v[76:77], v[128:129], v[136:137]
v_pk_mul_f32 v[138:139], v[90:91], v[114:115]
v_pk_mul_f32 v[140:141], v[92:93], v[116:117]
v_pk_fma_f32 v[138:139], v[86:87], v[118:119], v[138:139]
v_pk_fma_f32 v[140:141], v[88:89], v[120:121], v[140:141]
v_pk_fma_f32 v[138:139], v[82:83], v[122:123], v[138:139]
v_pk_fma_f32 v[140:141], v[84:85], v[124:125], v[140:141]
v_pk_fma_f32 v[138:139], v[78:79], v[126:127], v[138:139]
v_pk_fma_f32 v[140:141], v[80:81], v[128:129], v[140:141]
v_pk_mul_f32 v[142:143], v[94:95], v[114:115]
v_pk_mul_f32 v[144:145], v[96:97], v[116:117]
v_pk_fma_f32 v[142:143], v[90:91], v[118:119], v[142:143]
v_pk_fma_f32 v[144:145], v[92:93], v[120:121], v[144:145]
v_pk_fma_f32 v[142:143], v[86:87], v[122:123], v[142:143]
v_pk_fma_f32 v[144:145], v[88:89], v[124:125], v[144:145]
v_pk_fma_f32 v[142:143], v[82:83], v[126:127], v[142:143]
v_pk_fma_f32 v[144:145], v[84:85], v[128:129], v[144:145]
v_pk_mul_f32 v[146:147], v[98:99], v[114:115]
v_pk_mul_f32 v[148:149], v[100:101], v[116:117]
v_pk_fma_f32 v[146:147], v[94:95], v[118:119], v[146:147]
v_pk_fma_f32 v[148:149], v[96:97], v[120:121], v[148:149]
v_pk_fma_f32 v[146:147], v[90:91], v[122:123], v[146:147]
v_pk_fma_f32 v[148:149], v[92:93], v[124:125], v[148:149]
v_pk_fma_f32 v[146:147], v[86:87], v[126:127], v[146:147]
v_pk_fma_f32 v[148:149], v[88:89], v[128:129], v[148:149]
v_pk_mul_f32 v[150:151], v[102:103], v[114:115]
v_pk_mul_f32 v[152:153], v[104:105], v[116:117]
v_pk_fma_f32 v[150:151], v[98:99], v[118:119], v[150:151]
v_pk_fma_f32 v[152:153], v[100:101], v[120:121], v[152:153]
v_pk_fma_f32 v[150:151], v[94:95], v[122:123], v[150:151]
v_pk_fma_f32 v[152:153], v[96:97], v[124:125], v[152:153]
v_pk_fma_f32 v[150:151], v[90:91], v[126:127], v[150:151]
v_pk_fma_f32 v[152:153], v[92:93], v[128:129], v[152:153]
v_pk_mul_f32 v[154:155], v[106:107], v[114:115]
v_pk_mul_f32 v[156:157], v[108:109], v[116:117]
v_pk_fma_f32 v[154:155], v[102:103], v[118:119], v[154:155]
v_pk_fma_f32 v[156:157], v[104:105], v[120:121], v[156:157]
v_pk_fma_f32 v[154:155], v[98:99], v[122:123], v[154:155]
v_pk_fma_f32 v[156:157], v[100:101], v[124:125], v[156:157]
v_pk_fma_f32 v[154:155], v[94:95], v[126:127], v[154:155]
v_pk_fma_f32 v[156:157], v[96:97], v[128:129], v[156:157]
v_pk_mul_f32 v[158:159], v[110:111], v[114:115]
v_pk_mul_f32 v[160:161], v[112:113], v[116:117]
v_pk_fma_f32 v[158:159], v[106:107], v[118:119], v[158:159]
v_pk_fma_f32 v[160:161], v[108:109], v[120:121], v[160:161]
v_pk_fma_f32 v[158:159], v[102:103], v[122:123], v[158:159]
v_pk_fma_f32 v[160:161], v[104:105], v[124:125], v[160:161]
v_pk_fma_f32 v[158:159], v[98:99], v[126:127], v[158:159]
v_pk_fma_f32 v[160:161], v[100:101], v[128:129], v[160:161]
v_add_u32 v9, 35360, v9
v_add_u32 v10, 512, v10
s_cmp_eq_u32 s59, 262144
s_cbranch_scc1 LS_a1
s_waitcnt vmcnt(9) lgkmcnt(0)
s_barrier
LR_a0:
ds_read_b128 v[62:65], v10 offset:0
ds_read_b128 v[66:69], v10 offset:16
ds_read_b64 v[24:25], v9 offset:640
ds_read_b64 v[26:27], v9 offset:768
ds_read_b64 v[28:29], v9 offset:896
ds_read_b64 v[30:31], v9 offset:1040
ds_read_b64 v[32:33], v9 offset:1168
ds_read_b64 v[34:35], v9 offset:1296
ds_read_b64 v[36:37], v9 offset:1424
ds_read_b64 v[38:39], v9 offset:1552
ds_read_b64 v[40:41], v9 offset:1680
ds_read_b64 v[42:43], v9 offset:1808
ds_read_b64 v[44:45], v9 offset:1936
v_lshlrev_b32 v162, 16, v46
v_and_b32 v163, 0xffff0000, v46
v_pk_mul_f32 v[130:131], v[130:131], v[162:163]
v_lshlrev_b32 v164, 16, v48
v_and_b32 v165, 0xffff0000, v48
v_pk_mul_f32 v[134:135], v[134:135], v[164:165]
v_lshlrev_b32 v162, 16, v50
v_and_b32 v163, 0xffff0000, v50
v_pk_mul_f32 v[138:139], v[138:139], v[162:163]
v_lshlrev_b32 v164, 16, v52
v_and_b32 v165, 0xffff0000, v52
v_pk_mul_f32 v[142:143], v[142:143], v[164:165]
v_lshlrev_b32 v162, 16, v54
v_and_b32 v163, 0xffff0000, v54
v_pk_mul_f32 v[146:147], v[146:147], v[162:163]
v_lshlrev_b32 v164, 16, v56
v_and_b32 v165, 0xffff0000, v56
v_pk_mul_f32 v[150:151], v[150:151], v[164:165]
v_lshlrev_b32 v162, 16, v58
v_and_b32 v163, 0xffff0000, v58
v_pk_mul_f32 v[154:155], v[154:155], v[162:163]
v_lshlrev_b32 v164, 16, v60
v_and_b32 v165, 0xffff0000, v60
v_pk_mul_f32 v[158:159], v[158:159], v[164:165]
v_cvt_pk_bf16_f32 v72, v158, v154
v_cvt_pk_bf16_f32 v73, v150, v146
v_cvt_pk_bf16_f32 v74, v142, v138
v_cvt_pk_bf16_f32 v75, v134, v130
v_cvt_pk_bf16_f32 v76, v159, v155
v_cvt_pk_bf16_f32 v77, v151, v147
v_cvt_pk_bf16_f32 v78, v143, v139
v_cvt_pk_bf16_f32 v79, v135, v131
buffer_store_dwordx4 v[72:75], v11, s[44:47], s59 offen sc1
buffer_store_dwordx4 v[76:79], v12, s[44:47], s59 offen sc1
v_lshlrev_b32 v162, 16, v47
v_and_b32 v163, 0xffff0000, v47
v_pk_mul_f32 v[132:133], v[132:133], v[162:163]
v_lshlrev_b32 v164, 16, v49
v_and_b32 v165, 0xffff0000, v49
v_pk_mul_f32 v[136:137], v[136:137], v[164:165]
v_lshlrev_b32 v162, 16, v51
v_and_b32 v163, 0xffff0000, v51
v_pk_mul_f32 v[140:141], v[140:141], v[162:163]
v_lshlrev_b32 v164, 16, v53
v_and_b32 v165, 0xffff0000, v53
v_pk_mul_f32 v[144:145], v[144:145], v[164:165]
v_lshlrev_b32 v162, 16, v55
v_and_b32 v163, 0xffff0000, v55
v_pk_mul_f32 v[148:149], v[148:149], v[162:163]
v_lshlrev_b32 v164, 16, v57
v_and_b32 v165, 0xffff0000, v57
v_pk_mul_f32 v[152:153], v[152:153], v[164:165]
v_lshlrev_b32 v162, 16, v59
v_and_b32 v163, 0xffff0000, v59
v_pk_mul_f32 v[156:157], v[156:157], v[162:163]
v_lshlrev_b32 v164, 16, v61
v_and_b32 v165, 0xffff0000, v61
v_pk_mul_f32 v[160:161], v[160:161], v[164:165]
v_cvt_pk_bf16_f32 v80, v160, v156
v_cvt_pk_bf16_f32 v81, v152, v148
v_cvt_pk_bf16_f32 v82, v144, v140
v_cvt_pk_bf16_f32 v83, v136, v132
v_cvt_pk_bf16_f32 v84, v161, v157
v_cvt_pk_bf16_f32 v85, v153, v149
v_cvt_pk_bf16_f32 v86, v145, v141
v_cvt_pk_bf16_f32 v87, v137, v133
buffer_store_dwordx4 v[80:83], v13, s[44:47], s59 offen sc1
buffer_store_dwordx4 v[84:87], v14, s[44:47], s59 offen sc1
s_add_u32 s59, s59, 262144
s_cmp_lt_u32 s59, 786432
s_cbranch_scc1 LA_loop
buffer_load_dword v255, v15, s[44:47], 0 offen sc1
v_subrev_u32 v210, 8, v19
v_min_u32 v210, 2147483648, v210
buffer_load_dwordx2 v[192:193], v210, s[20:23], s72 offen
buffer_load_dwordx4 v[194:197], v19, s[20:23], s72 offen
buffer_load_dwordx2 v[198:199], v210, s[20:23], s73 offen
buffer_load_dwordx4 v[200:203], v19, s[20:23], s73 offen
buffer_load_dwordx2 v[204:205], v210, s[20:23], s74 offen
buffer_load_dwordx4 v[206:209], v19, s[20:23], s74 offen
buffer_load_ushort v211, v239, s[20:23], 0 offen
v_lshrrev_b32 v239, 11, v239
buffer_load_ushort v253, v239, s[24:27], 0 offen
s_lshl_b32 s65, s53, 3
s_lshl_b32 s66, s75, 2
s_add_u32 s65, s65, s66
s_lshl_b32 s3, s65, 5
s_add_u32 s3, s3, 5275648
v_mov_b32 v218, s3
s_add_u32 s67, s50, s54
s_and_b32 s67, s67, 3
s_mul_i32 s64, s75, 28
s_mul_i32 s62, s50, 7
s_add_u32 s64, s64, s62
s_xor_b32 s66, s65, 4
s_sub_u32 s12, s65, s66
s_mul_i32 s12, s12, 57344
s_mul_i32 s66, s66, 56
s_add_u32 s66, s66, s64
s_lshl_b32 s66, s66, 10
s_add_u32 s66, s66, 6291456
s_add_u32 s3, s67, 1
s_and_b32 s3, s3, 3
s_mul_i32 s62, s3, 57344
s_add_u32 s8, s62, s66
s_mul_i32 s3, s3, 15360
s_add_u32 s13, s3, 0
s_add_u32 s3, s67, 2
s_and_b32 s3, s3, 3
s_mul_i32 s62, s3, 57344
s_add_u32 s9, s62, s66
s_mul_i32 s3, s3, 15360
s_add_u32 s14, s3, 5120
s_add_u32 s3, s67, 3
s_and_b32 s3, s3, 3
s_mul_i32 s62, s3, 57344
s_add_u32 s10, s62, s66
s_mul_i32 s3, s3, 15360
s_add_u32 s15, s3, 10240
s_add_u32 s3, s67, 4
s_and_b32 s3, s3, 3
s_mul_i32 s62, s3, 57344
s_add_u32 s11, s62, s66
s_lshl_b32 s3, s50, 12
s_add_u32 s62, s3, 140800
v_add_u32 v222, s62, v18
s_xor_b32 s62, s3, 4096
s_add_u32 s62, s62, 140800
v_add_u32 v223, s62, v18
s_lshr_b32 s3, s3, 13
s_lshl_b32 s3, s3, 12
s_add_u32 s3, s3, s72
s_add_u32 s69, s3, 2621440
v_and_b32 v20, 15, v1
v_lshrrev_b32 v21, 4, v1
v_and_b32 v22, 1, v21
v_lshlrev_b32 v217, 9, v22
v_lshl_add_u32 v217, v20, 5, v217
v_lshrrev_b32 v22, 1, v21
v_lshl_add_u32 v217, v22, 4, v217
s_lshl_b32 s3, s48, 7
s_add_u32 s3, s3, 5279744
v_or_b32 v241, s3, v2
v_lshlrev_b32 v235, 3, v1
s_lshl_b32 s3, s2, 2
s_add_u32 s3, s3, s50
s_mul_i32 s19, s3, 3072
s_add_u32 s19, s19, 13631488
s_xor_b32 s62, s3, 16
s_mul_i32 s18, s62, 3072
s_add_u32 s18, s18, 13631488
s_lshr_b32 s3, s62, 4
s_lshl_b32 s3, s3, 7
s_and_b32 s62, s62, 15
s_lshl_b32 s62, s62, 2
s_add_u32 s3, s3, s62
s_add_u32 s3, s3, 5280768
v_min_u32 v20, 1, v1
v_lshl_or_b32 v234, v20, 31, s3
s_xor_b32 s3, s3, 128
v_mov_b32 v237, s3
v_cmp_eq_u32 vcc, 1, v0
v_and_b32 v20, 0x7fffffff, v241
s_nop 0
v_cndmask_b32 v234, v234, v20, vcc
v_accvgpr_write_b32 a252, -1
v_accvgpr_write_b32 a253, -1
v_accvgpr_write_b32 a254, -1
v_accvgpr_write_b32 a255, -1
s_and_b32 s16, s50, 1
s_lshl_b32 s16, s16, 11
s_add_u32 s16, s16, s69
v_mov_b32 v24, 0
v_mov_b32 v25, 0
v_mov_b32 v26, 0
v_mov_b32 v27, 0
v_min_u32 v36, 39, v1
v_lshrrev_b32 v37, 5, v36
v_bfe_u32 v38, v36, 1, 2
v_mul_u32_u24 v38, 4128, v38
v_subrev_u32 v38, 21248, v38
v_mul_i32_i24 v38, v37, v38
v_lshl_add_u32 v28, v36, 4, v38
s_min_u32 s3, s50, 2
s_mul_i32 s3, s3, 21248
s_add_u32 s3, s3, 119040
v_add_u32 v28, s3, v28
s_cmp_eq_u32 s63, 0
s_cbranch_scc1 LS_iA
LR_iA:
s_waitcnt vmcnt(9) lgkmcnt(0)
s_barrier
buffer_atomic_add v242, v254, s[44:47], 0 offen sc1
s_add_u32 m0, s70, 16384
s_nop 0
buffer_load_dwordx4 v244, s[32:35], s71 offen offset:0 lds
buffer_load_dwordx4 v245, s[32:35], s71 offen offset:1024 lds
buffer_load_dwordx4 v246, s[32:35], s71 offen offset:2048 lds
buffer_load_dwordx4 v247, s[32:35], s71 offen offset:3072 lds
s_add_u32 s71, s71, 40960
s_sub_u32 s63, s71, 286720
s_min_u32 s71, s71, s63
s_add_u32 m0, s70, 65536
s_nop 0
buffer_load_dwordx4 v244, s[32:35], s71 offen offset:0 lds
buffer_load_dwordx4 v245, s[32:35], s71 offen offset:1024 lds
buffer_load_dwordx4 v246, s[32:35], s71 offen offset:2048 lds
buffer_load_dwordx4 v247, s[32:35], s71 offen offset:3072 lds
s_add_u32 s71, s71, 40960
s_sub_u32 s63, s71, 286720
s_min_u32 s71, s71, s63
s_waitcnt vmcnt(9)
v_alignbit_b32 v180, v194, v193, 16
v_alignbit_b32 v181, v195, v194, 16
v_alignbit_b32 v182, v196, v195, 16
v_alignbit_b32 v183, v197, v196, 16
v_accvgpr_write_b32 a240, v193
v_accvgpr_write_b32 a241, v194
v_accvgpr_write_b32 a242, v195
v_accvgpr_write_b32 a243, v196
v_alignbit_b32 v184, v193, v192, 16
v_alignbit_b32 v185, v194, v193, 16
v_alignbit_b32 v186, v195, v194, 16
v_alignbit_b32 v187, v196, v195, 16
v_alignbit_b32 v188, v200, v199, 16
v_alignbit_b32 v189, v201, v200, 16
v_alignbit_b32 v190, v202, v201, 16
v_alignbit_b32 v191, v203, v202, 16
v_accvgpr_write_b32 a244, v199
v_accvgpr_write_b32 a245, v200
v_accvgpr_write_b32 a246, v201
v_accvgpr_write_b32 a247, v202
v_alignbit_b32 v164, v199, v198, 16
v_alignbit_b32 v165, v200, v199, 16
v_alignbit_b32 v166, v201, v200, 16
v_alignbit_b32 v167, v202, v201, 16
v_alignbit_b32 v168, v206, v205, 16
v_alignbit_b32 v169, v207, v206, 16
v_alignbit_b32 v170, v208, v207, 16
v_alignbit_b32 v171, v209, v208, 16
v_accvgpr_write_b32 a248, v205
v_accvgpr_write_b32 a249, v206
v_accvgpr_write_b32 a250, v207
v_accvgpr_write_b32 a251, v208
v_alignbit_b32 v224, v205, v204, 16
v_alignbit_b32 v225, v206, v205, 16
v_alignbit_b32 v226, v207, v206, 16
v_alignbit_b32 v227, v208, v207, 16
v_lshlrev_b32 v211, 16, v211
v_lshlrev_b32 v253, 16, v253
v_add_f32 v211, v211, v253
v_cvt_pk_bf16_f32 v211, v211, v211
ds_write_b128 v28, v[24:27]
ds_write_b128 v219, v[194:197] offset:32
ds_write_b128 v219, v[180:183] offset:4192
ds_write_b128 v219, a[240:243] offset:8352
ds_write_b128 v219, v[184:187] offset:12512
ds_write_b128 v219, v[200:203] offset:21280
ds_write_b128 v219, v[188:191] offset:25440
ds_write_b128 v219, a[244:247] offset:29600
ds_write_b128 v219, v[164:167] offset:33760
ds_write_b128 v219, v[206:209] offset:42528
ds_write_b128 v219, v[168:171] offset:46688
ds_write_b128 v219, a[248:251] offset:50848
ds_write_b128 v219, v[224:227] offset:55008
ds_write_b16 v240, v211
s_lshl_b32 s25, s75, 2
s_add_u32 s25, s25, s50
s_lshl_b32 s25, s25, 7
s_add_u32 s25, s25, 5292288
s_load_dword s24, s[44:45], s25
v_lshl_add_u32 v4, s60, 10, v18
v_add_u32 v5, 1024, v4
v_subrev_u32 v11, 7168, v5
v_min_u32 v5, v5, v11
v_add_u32 v6, 1024, v5
v_subrev_u32 v11, 7168, v6
v_min_u32 v6, v6, v11
v_add_u32 v7, 1024, v6
v_subrev_u32 v11, 7168, v7
v_min_u32 v7, v7, v11
v_add_u32 v8, 1024, v7
v_subrev_u32 v11, 7168, v8
v_min_u32 v8, v8, v11
v_add_u32 v9, 1024, v8
v_subrev_u32 v11, 7168, v9
v_min_u32 v9, v9, v11
v_add_u32 v10, 1024, v9
v_subrev_u32 v11, 7168, v10
v_min_u32 v10, v10, v11
v_mov_b32 v254, 2147483648
s_waitcnt lgkmcnt(0)
s_cmp_eq_u32 s24, 14
s_cbranch_scc0 LS_faA
LR_faA:
buffer_load_dwordx4 a[16:19], v4, s[44:47], s17 offen sc1
buffer_load_dwordx4 a[36:39], v5, s[44:47], s17 offen sc1
s_branch L_conv
LS_iG:
s_mov_b32 s61, 0
LS2_iG:
buffer_load_dword v250, off, s[40:43], 0 offset:128 sc1
s_add_u32 s61, s61, 1
s_waitcnt vmcnt(0)
v_cmp_ne_u32 vcc, 1, v250
s_cmp_lt_u32 s61, 200000
s_cbranch_vccz LS3_iG
s_sleep 2
s_cbranch_scc1 LS2_iG
LS3_iG:

s_branch LR_iG
LS_fs:
s_mov_b32 s61, 0
LS2_fs:
buffer_load_dword v252, v251, s[44:47], 0 offen sc1
s_add_u32 s61, s61, 1
s_waitcnt vmcnt(0)
v_cmp_ne_u32 vcc, 6, v252
s_cmp_lt_u32 s61, 200000
s_cbranch_vccz LS3_fs
s_sleep 2
s_cbranch_scc1 LS2_fs
LS3_fs:

s_branch LR_fs
LS_fa:
s_mov_b32 s61, 0
LS2_fa:
buffer_load_dword v252, off, s[44:47], s25 sc1
s_add_u32 s61, s61, 1
s_waitcnt vmcnt(0)
v_cmp_ne_u32 vcc, 14, v252
s_cmp_lt_u32 s61, 200000
s_cbranch_vccz LS3_fa
s_sleep 4
s_cbranch_scc1 LS2_fa
LS3_fa:

s_branch LR_fa
LS_fk:
s_mov_b32 s61, 0
LS2_fk:
buffer_load_dword v252, v238, s[44:47], 0 offen sc1
s_add_u32 s61, s61, 1
s_waitcnt vmcnt(0)
v_cmp_ne_u32 vcc, 32, v252
s_cmp_lt_u32 s61, 200000
s_cbranch_vccz LS3_fk
s_sleep 4
s_cbranch_scc1 LS2_fk
LS3_fk:
s_lshl_b32 s62, s50, 10
s_add_u32 m0, s62, 114944
s_nop 0
buffer_load_dwordx4 v19, s[44:47], s72 offen sc1 lds
s_add_u32 m0, s62, 136192
s_nop 0
buffer_load_dwordx4 v19, s[44:47], s73 offen sc1 lds
s_add_u32 m0, s62, 157440
s_nop 0
buffer_load_dwordx4 v19, s[44:47], s74 offen sc1 lds
s_waitcnt vmcnt(0)
s_branch LR_fk
LS_f20:
s_mov_b32 s61, 0
LS2_f20:
buffer_load_dword v252, off, s[44:47], s24 sc1
s_add_u32 s61, s61, 1
s_waitcnt vmcnt(0)
v_cmp_ne_u32 vcc, 7, v252
s_cmp_lt_u32 s61, 200000
s_cbranch_vccz LS3_f20
s_sleep 2
s_cbranch_scc1 LS2_f20
LS3_f20:

s_branch LR_f20
LS_f21:
s_mov_b32 s61, 0
LS2_f21:
buffer_load_dword v252, off, s[44:47], s24 sc1
s_add_u32 s61, s61, 1
s_waitcnt vmcnt(0)
v_cmp_ne_u32 vcc, 7, v252
s_cmp_lt_u32 s61, 200000
s_cbranch_vccz LS3_f21
s_sleep 2
s_cbranch_scc1 LS2_f21
LS3_f21:

s_branch LR_f21
LS_f4:
s_mov_b32 s61, 0
LS2_f4:
buffer_load_dword v252, off, s[44:47], s26 sc1
s_add_u32 s61, s61, 1
s_waitcnt vmcnt(0)
v_cmp_ne_u32 vcc, 1, v252
s_cmp_lt_u32 s61, 200000
s_cbranch_vccz LS3_f4
s_sleep 2
s_cbranch_scc1 LS2_f4
LS3_f4:

s_branch LR_f4
LS_f30:
s_mov_b32 s61, 0
LS2_f30:
buffer_load_dword v252, off, s[44:47], s28 sc1
s_add_u32 s61, s61, 1
s_waitcnt vmcnt(0)
v_cmp_ne_u32 vcc, 32, v252
s_cmp_lt_u32 s61, 200000
s_cbranch_vccz LS3_f30
s_sleep 6
s_cbranch_scc1 LS2_f30
LS3_f30:

s_branch LR_f30
LS_f31:
s_mov_b32 s61, 0
LS2_f31:
buffer_load_dword v252, off, s[44:47], s29 sc1
s_add_u32 s61, s61, 1
s_waitcnt vmcnt(0)
v_cmp_ne_u32 vcc, 32, v252
s_cmp_lt_u32 s61, 200000
s_cbranch_vccz LS3_f31
s_sleep 6
s_cbranch_scc1 LS2_f31
LS3_f31:

s_branch LR_f31
LS_f32:
s_mov_b32 s61, 0
LS2_f32:
buffer_load_dword v252, off, s[44:47], s30 sc1
s_add_u32 s61, s61, 1
s_waitcnt vmcnt(0)
v_cmp_ne_u32 vcc, 32, v252
s_cmp_lt_u32 s61, 200000
s_cbranch_vccz LS3_f32
s_sleep 6
s_cbranch_scc1 LS2_f32
LS3_f32:

s_branch LR_f32
LS_y:
s_mov_b32 s61, 0
s_lshl_b32 s3, s50, 15
v_subrev_u32 v16, s3, v227
LS2_y:
s_mov_b32 m0, 122880
s_add_u32 s3, 0, 0
buffer_load_dwordx4 v16, s[44:47], s3 offen sc1 lds
s_mov_b32 m0, 123904
s_add_u32 s3, 0, 32768
buffer_load_dwordx4 v16, s[44:47], s3 offen sc1 lds
s_mov_b32 m0, 124928
s_add_u32 s3, 0, 65536
buffer_load_dwordx4 v16, s[44:47], s3 offen sc1 lds
s_mov_b32 m0, 125952
s_add_u32 s3, 0, 98304
buffer_load_dwordx4 v16, s[44:47], s3 offen sc1 lds
s_mov_b32 m0, 126976
s_add_u32 s3, 0, 131072
buffer_load_dwordx4 v16, s[44:47], s3 offen sc1 lds
s_mov_b32 m0, 128000
s_add_u32 s3, 0, 163840
buffer_load_dwordx4 v16, s[44:47], s3 offen sc1 lds
s_mov_b32 m0, 129024
s_add_u32 s3, 0, 196608
buffer_load_dwordx4 v16, s[44:47], s3 offen sc1 lds
s_mov_b32 m0, 130048
s_add_u32 s3, 0, 229376
buffer_load_dwordx4 v16, s[44:47], s3 offen sc1 lds
s_mov_b32 m0, 131072
s_add_u32 s3, s31, 0
buffer_load_dwordx4 v16, s[44:47], s3 offen sc1 lds
s_mov_b32 m0, 132096
s_add_u32 s3, s31, 32768
buffer_load_dwordx4 v16, s[44:47], s3 offen sc1 lds
s_add_u32 s61, s61, 1
s_waitcnt vmcnt(0)
ds_read_b64_tr_b16 v[118:119], v229 offset:0
ds_read_b64_tr_b16 v[120:121], v229 offset:2048
ds_read_b64_tr_b16 v[122:123], v229 offset:4096
ds_read_b64_tr_b16 v[124:125], v229 offset:6144
ds_read_b64_tr_b16 v[126:127], v229 offset:8192
s_waitcnt lgkmcnt(0)
v_pk_max_u16 v14, v118, v119
v_pk_max_u16 v15, v120, v121
v_pk_max_u16 v14, v14, v122
v_pk_max_u16 v15, v15, v123
v_pk_max_u16 v14, v14, v124
v_pk_max_u16 v15, v15, v125
v_pk_max_u16 v14, v14, v126
v_pk_max_u16 v15, v15, v127
v_pk_max_u16 v14, v14, v15
v_pk_max_u16 v14, v14, v14 op_sel:[1,0] op_sel_hi:[0,1]
v_cmp_eq_u32 vcc, -1, v14
s_cmp_lt_u32 s61, 200000
s_cbranch_vccz LR_y
s_cbranch_scc1 LS2_y
s_branch LR_y
LS_p:
s_mov_b32 s61, 0
LS2_p:
buffer_load_dwordx4 v[104:107], v18, s[44:47], s19 offen sc1
buffer_load_dwordx4 v[108:111], v18, s[44:47], s19 offen offset:1024 sc1
buffer_load_dwordx2 v[112:113], v235, s[44:47], s19 offen offset:2048 sc1
s_add_u32 s61, s61, 1
s_waitcnt vmcnt(0)
v_max3_u32 v20, v104, v105, v106
v_max3_u32 v21, v107, v108, v109
v_max3_u32 v20, v20, v110, v111
v_max3_u32 v21, v21, v112, v113
v_max_u32 v20, v20, v21
v_cmp_eq_u32 vcc, -1, v20
s_cmp_lt_u32 s61, 200000
s_cbranch_vccz LR_p
s_cbranch_scc1 LS2_p
s_branch LR_p
LS_init:
v_mov_b32 v20, 0
v_mov_b32 v21, 0
v_mov_b32 v22, 0
v_mov_b32 v23, 0
s_load_dwordx2 s[40:41], s[0:1], 80
s_mov_b32 s42, 256
s_mov_b32 s43, 0x20000
s_mov_b32 s63, 5275648
buffer_store_dwordx4 v[20:23], v19, s[44:47], s63 offen sc1
s_mov_b32 s63, 5279744
buffer_store_dwordx4 v[20:23], v19, s[44:47], s63 offen sc1
s_mov_b32 s63, 5283840
buffer_store_dwordx4 v[20:23], v19, s[44:47], s63 offen sc1
s_mov_b32 s63, 5287936
buffer_store_dwordx4 v[20:23], v19, s[44:47], s63 offen sc1
s_mov_b32 s63, 5292032
buffer_store_dwordx4 v[20:23], v19, s[44:47], s63 offen sc1
v_lshlrev_b32 v24, 6, v0
v_mov_b32 v25, 1
s_waitcnt vmcnt(0) lgkmcnt(0)
s_barrier
buffer_atomic_add v25, v24, s[40:43], 0 offen sc1
s_branch LR_init
LS_a1:
s_waitcnt vmcnt(4) lgkmcnt(0)
s_barrier
s_load_dword s63, s[40:41], 64

s_branch LR_a0
LS_iA:
s_mov_b32 s61, 0
LS2_iA:
buffer_load_dword v250, off, s[40:43], 0 offset:128 sc1
s_add_u32 s61, s61, 1
s_waitcnt vmcnt(0)
v_cmp_ne_u32 vcc, 1, v250
s_cmp_lt_u32 s61, 200000
s_cbranch_vccz LS3_iA
s_sleep 2
s_cbranch_scc1 LS2_iA
LS3_iA:

s_branch LR_iA
LS_faA:
s_mov_b32 s61, 0
LS2_faA:
buffer_load_dword v252, off, s[44:47], s25 sc1
s_add_u32 s61, s61, 1
s_waitcnt vmcnt(0)
v_cmp_ne_u32 vcc, 14, v252
s_cmp_lt_u32 s61, 200000
s_cbranch_vccz LS3_faA
s_sleep 4
s_cbranch_scc1 LS2_faA
LS3_faA:

s_branch LR_faA
L_pad:
.fill (40960 - (L_pad - parallel_sum__ssm_conv_h3__dense_activation_silu__prompt_kernel))/4, 4, 0xbf810000
.section .rodata,"a"
.p2align 6

.amdhsa_kernel parallel_sum__ssm_conv_h3__dense_activation_silu__prompt_kernel
  .amdhsa_next_free_vgpr 512
  .amdhsa_next_free_sgpr 102
  .amdhsa_accum_offset 256
  .amdhsa_group_segment_fixed_size 0
  .amdhsa_kernarg_size 96
  .amdhsa_user_sgpr_count 2
  .amdhsa_user_sgpr_kernarg_segment_ptr 1
  .amdhsa_system_sgpr_workgroup_id_x 1
.end_amdhsa_kernel
```
